```python
import torch

def _softmax(x, axis=-1):
    return torch.softmax(x, dim=axis)
def _gelu(x):
    return torch.nn.functional.gelu(x, approximate="tanh")
def _silu(x):
    return torch.nn.functional.silu(x)
def _sigmoid(x):
    return torch.sigmoid(x)
def _layernorm(x, axis=-1, eps=1e-5):
    m = x.mean(dim=axis, keepdim=True)
    v = x.var(dim=axis, keepdim=True, unbiased=False)
    return (x - m) / torch.sqrt(v + eps)
def _scatter_add(tgt, idx, src, axis=0):
    return tgt.clone().index_add_(axis, idx, src)
def _segment_sum(src, seg, n):
    out = torch.zeros((n,) + src.shape[1:], dtype=src.dtype)
    return out.index_add_(0, seg, src)
def _pad(x, pw):
    flat = tuple(v for pair in reversed(pw) for v in pair)
    return torch.nn.functional.pad(x, flat)

kernel_name = 'standalone__gqa_block_cached__near_ridge'

def setup_inputs():

    _w = (lambda a: (lambda t: t.to(torch.bfloat16) if t.is_floating_point() else t)(torch.as_tensor(a)))
    B, Sq, D = 8, 160, 576
    Hq, Hkv, Sk, Dh = 32, 16, 2048, 128
    assert Hq % Hkv == 0, (Hq, Hkv)
    return {
        "x": _w((lambda *s: torch.randn(*s, dtype=torch.bfloat16) * 0.8)(B, Sq, D)),
        "k_cache": _w((lambda *s: torch.randn(*s, dtype=torch.bfloat16) * 0.8)(B, Hkv, Sk, Dh)),
        "v_cache": _w((lambda *s: torch.randn(*s, dtype=torch.bfloat16) * 0.05)(B, Hkv, Sk, Dh)),
        "wq": _w((lambda *s: torch.randn(*s, dtype=torch.bfloat16) * 0.8)(D, Hq * Dh) * (D ** -0.5)),
        "wo": _w((lambda *s: torch.randn(*s, dtype=torch.bfloat16) * 0.05)(Hq * Dh, D) * ((Hq * Dh) ** -0.5)),
    }

def reference(x, k_cache, v_cache, wq, wo):
    B, Sq, D = x.shape
    Hq, Dh = 32, 128
    Hkv = k_cache.shape[1]
    rep = Hq // Hkv
    q = (lambda x, *d: x.permute(*d))((x @ wq).reshape(B, Sq, Hq, Dh), 0, 2, 1, 3)
    k = (lambda x, n, axis: torch.repeat_interleave(x, n, dim=axis))(k_cache, rep, axis=1)
    v = (lambda x, n, axis: torch.repeat_interleave(x, n, dim=axis))(v_cache, rep, axis=1)
    scores = torch.einsum("bhqd,bhkd->bhqk", q, k) * (Dh ** -0.5)
    p = _softmax(scores, axis=-1)
    o = torch.einsum("bhqk,bhkd->bhqd", p, v)
    return (lambda x, *d: x.permute(*d))(o, 0, 2, 1, 3).reshape(B, Sq, Hq * Dh) @ wo
```

```asm
; @launch grid=(256,1,1) block=(256,1,1) lds=163840
.amdgcn_target "amdgcn-amd-amdhsa--gfx950"
.text
.globl standalone__gqa_block_cached__near_ridge_kernel
.p2align 8
.type standalone__gqa_block_cached__near_ridge_kernel,@function
standalone__gqa_block_cached__near_ridge_kernel:
    s_cmp_ge_u32 s2, 256
    s_cbranch_scc1 L_k1_end
    s_load_dwordx2 s[8:9], s[0:1], 0
    s_load_dwordx2 s[20:21], s[0:1], 24
    s_load_dwordx2 s[12:13], s[0:1], 8
    s_load_dwordx2 s[16:17], s[0:1], 16
    s_load_dwordx2 s[24:25], s[0:1], 56
    s_load_dwordx2 s[52:53], s[0:1], 32
    s_load_dwordx2 s[56:57], s[0:1], 40
    s_load_dwordx2 s[92:93], s[0:1], 48
    s_mov_b32 s58, 1474560
    s_mov_b32 s59, 0x00020000
    s_mov_b32 s94, 256
    s_mov_b32 s95, 0x00020000
    v_lshrrev_b32 v1, 6, v0
    v_and_b32 v2, 63, v0
    s_mov_b32 s10, 1474560
    s_mov_b32 s11, 0x00020000
    v_readfirstlane_b32 s3, v1
    s_mov_b32 s22, 4718592
    s_mov_b32 s23, 0x00020000
    s_mov_b32 s14, 0x4000000
    s_mov_b32 s15, 0x00020000
    s_mov_b32 s18, 0x4000000
    s_mov_b32 s19, 0x00020000
    s_mov_b32 s26, 10485760
    s_mov_b32 s27, 0x00020000
    s_mov_b32 s54, 4718592
    s_mov_b32 s55, 0x00020000
    s_and_b32 s34, s2, 7
    s_lshr_b32 s35, s2, 3
    s_and_b32 s36, s35, 3
    s_lshl_b32 s6, s34, 2
    s_add_u32 s6, s6, s36
    s_lshr_b32 s7, s35, 2
    s_and_b32 s4, s3, 1
    s_lshr_b32 s5, s3, 1
    s_add_u32 s37, s7, s36
    s_mul_i32 s38, s37, 43
    s_lshr_b32 s38, s38, 7
    s_mul_i32 s38, s38, 3
    s_sub_u32 s37, s37, s38
    s_mul_i32 s37, s37, 3
    s_mul_i32 s40, s7, 184320
    s_lshl_b32 s41, s6, 8
    s_add_u32 s42, s40, 1152
    s_lshl_b32 s38, s37, 7
    s_add_u32 s46, s40, s38
    s_lshl_b32 s38, s37, 19
    s_add_u32 s47, s41, s38
    s_lshl_b32 s34, s3, 3
    v_lshrrev_b32 v244, 3, v2
    v_add_u32 v244, s34, v244
    v_mul_u32_u24 v244, 1152, v244
    v_and_b32 v245, 7, v2
    v_lshrrev_b32 v246, 4, v2
    v_xor_b32 v245, v245, v246
    s_lshl_b32 s35, s4, 2
    v_xor_b32 v245, s35, v245
    v_lshl_add_u32 v3, v245, 4, v244
    v_add_u32 v4, 36864, v3
    v_add_u32 v5, 73728, v3
    v_add_u32 v6, 110592, v3
    v_add_u32 v7, 147456, v3
    s_lshl_b32 s34, s3, 2
    v_add_u32 v244, s34, v246
    v_lshlrev_b32 v244, 13, v244
    v_and_b32 v247, 15, v2
    v_lshlrev_b32 v245, 2, v246
    v_xor_b32 v245, v245, v247
    v_lshl_add_u32 v8, v245, 4, v244
    v_add_u32 v9, 131072, v8
    v_add_u32 v10, 262144, v8
    v_add_u32 v11, 393216, v8
    s_lshl_b32 s34, s3, 10
    s_add_u32 s49, s34, 81920
    s_add_u32 s50, s34, 16384
    s_waitcnt lgkmcnt(0)
    s_add_u32 m0, s50, 0
    s_nop 0
    buffer_load_dwordx4 v8, s[20:23], s47 offen lds
    s_add_u32 m0, s49, 0
    s_nop 0
    buffer_load_dwordx4 v3, s[8:11], s46 offen lds
    s_add_u32 m0, s50, 4096
    s_nop 0
    buffer_load_dwordx4 v9, s[20:23], s47 offen lds
    s_add_u32 m0, s49, 4096
    s_nop 0
    buffer_load_dwordx4 v4, s[8:11], s46 offen lds
    s_add_u32 m0, s50, 8192
    s_nop 0
    buffer_load_dwordx4 v10, s[20:23], s47 offen lds
    s_add_u32 m0, s49, 8192
    s_nop 0
    buffer_load_dwordx4 v5, s[8:11], s46 offen lds
    s_add_u32 m0, s50, 12288
    s_nop 0
    buffer_load_dwordx4 v11, s[20:23], s47 offen lds
    s_add_u32 m0, s49, 12288
    s_nop 0
    buffer_load_dwordx4 v6, s[8:11], s46 offen lds
    s_add_u32 m0, s49, 16384
    s_nop 0
    buffer_load_dwordx4 v7, s[8:11], s46 offen lds
    s_lshr_b32 s34, s6, 1
    s_lshl_b32 s35, s7, 4
    s_add_u32 s34, s34, s35
    s_lshl_b32 s34, s34, 19
    s_lshl_b32 s35, s5, 18
    s_add_u32 s34, s34, s35
    s_lshl_b32 s35, s4, 12
    s_add_u32 s100, s34, s35
    s_add_u32 s101, s100, 262144
    s_lshr_b32 s36, s6, 1
    s_lshl_b32 s37, s7, 4
    s_add_u32 s36, s36, s37
    s_mul_i32 s36, s36, 1
    s_lshl_b32 s37, s5, 4
    s_add_u32 s36, s36, s37
    s_and_b32 s36, s36, 31
    s_lshl_b32 s36, s36, 13
    s_add_u32 s46, s46, 128
    s_add_u32 s47, s47, 0x80000
    s_cmp_eq_u32 s46, s42
    s_cselect_b32 s46, s40, s46
    s_cselect_b32 s47, s41, s47
    s_add_u32 m0, s50, 16384
    s_nop 0
    buffer_load_dwordx4 v8, s[20:23], s47 offen lds
    s_add_u32 s48, s100, s36
    s_lshl_b32 s34, s5, 16
    s_add_u32 s31, s34, s35
    s_mov_b32 s33, 0
    v_lshrrev_b32 v246, 4, v2
    v_and_b32 v247, 15, v2
    v_lshlrev_b32 v244, 8, v246
    v_xor_b32 v245, v247, v246
    v_xor_b32 v248, 0, v245
    v_lshl_add_u32 v236, v248, 4, v244
    v_xor_b32 v248, 4, v245
    v_lshl_add_u32 v237, v248, 4, v244
    v_xor_b32 v248, 8, v245
    v_lshl_add_u32 v238, v248, 4, v244
    v_xor_b32 v248, 12, v245
    v_lshl_add_u32 v239, v248, 4, v244
    v_lshlrev_b32 v248, 1, v246
    v_xor_b32 v245, v247, v248
    s_add_u32 m0, s49, 20480
    s_nop 0
    buffer_load_dwordx4 v3, s[8:11], s46 offen lds
    v_xor_b32 v248, 0, v245
    v_lshl_add_u32 v240, v248, 4, v244
    v_xor_b32 v248, 8, v245
    v_lshl_add_u32 v241, v248, 4, v244
    s_lshl_b32 s34, s2, 2
    s_add_u32 s34, s34, s3
    s_mul_i32 s51, s34, 4608
    v_lshlrev_b32 v244, 4, v2
    v_mov_b32 v245, 0x7f000000
    v_cmp_gt_u32 vcc, 41, v2
    s_nop 1
    v_cndmask_b32 v255, v245, v244, vcc
    v_mov_b32 v255, v244
    s_lshl_b32 s34, s2, 2
    s_add_u32 s34, s34, s3
    s_lshr_b32 s35, s34, 8
    s_and_b32 s34, s34, 255
    s_mul_i32 s35, s35, 1179648
    s_add_u32 m0, s50, 20480
    s_nop 0
    buffer_load_dwordx4 v9, s[20:23], s47 offen lds
    s_mul_i32 s34, s34, 3456
    s_add_u32 s34, s34, s35
    s_add_u32 s51, s34, 294912
    v_lshrrev_b32 v246, 4, v2
    v_and_b32 v247, 15, v2
    v_lshrrev_b32 v249, 2, v2
    v_and_b32 v249, 3, v249
    v_and_b32 v250, 3, v2
    s_mul_i32 s34, s4, 10240
    s_add_u32 s34, s34, 81920
    v_lshlrev_b32 v244, 7, v247
    v_add_u32 v244, s34, v244
    v_lshrrev_b32 v245, 1, v247
    v_xor_b32 v248, v246, v245
    v_lshl_add_u32 v12, v248, 4, v244
    v_xor_b32 v248, 4, v248
    v_lshl_add_u32 v13, v248, 4, v244
    s_add_u32 m0, s49, 24576
    s_nop 0
    buffer_load_dwordx4 v4, s[8:11], s46 offen lds
    v_lshl_add_u32 v244, v246, 3, v249
    v_lshlrev_b32 v244, 8, v244
    v_add_u32 v244, 16384, v244
    s_lshl_b32 s34, s5, 1
    s_add_u32 s35, s34, 0
    v_xor_b32 v245, s35, v249
    v_lshl_add_u32 v245, v245, 2, v250
    v_lshl_add_u32 v14, v245, 4, v244
    s_add_u32 s35, s34, 1
    v_xor_b32 v245, s35, v249
    v_lshl_add_u32 v245, v245, 2, v250
    v_lshl_add_u32 v15, v245, 4, v244
    s_lshl_b32 s35, s5, 16
    v_lshlrev_b32 v244, 8, v247
    v_add_u32 v244, s35, v244
    s_xor_b32 s36, s34, 0
    s_lshl_b32 s36, s36, 2
    s_add_u32 m0, s50, 24576
    s_nop 0
    buffer_load_dwordx4 v10, s[20:23], s47 offen lds
    v_add_u32 v245, s36, v246
    v_xor_b32 v245, v245, v247
    v_lshl_add_u32 v224, v245, 4, v244
    s_xor_b32 s36, s34, 1
    s_lshl_b32 s36, s36, 2
    v_add_u32 v245, s36, v246
    v_xor_b32 v245, v245, v247
    v_lshl_add_u32 v225, v245, 4, v244
    s_xor_b32 s36, s34, 2
    s_lshl_b32 s36, s36, 2
    v_add_u32 v245, s36, v246
    v_xor_b32 v245, v245, v247
    v_lshl_add_u32 v226, v245, 4, v244
    s_xor_b32 s36, s34, 3
    s_lshl_b32 s36, s36, 2
    v_add_u32 v245, s36, v246
    v_xor_b32 v245, v245, v247
    v_lshl_add_u32 v227, v245, 4, v244
    s_add_u32 m0, s49, 28672
    s_nop 0
    buffer_load_dwordx4 v5, s[8:11], s46 offen lds
    v_lshl_add_u32 v244, v246, 2, v249
    v_lshlrev_b32 v244, 8, v244
    s_add_u32 s35, s35, 8192
    v_add_u32 v244, s35, v244
    v_and_b32 v245, 1, v250
    v_lshl_add_u32 v244, v245, 3, v244
    v_lshrrev_b32 v245, 1, v250
    v_lshl_add_u32 v244, v245, 4, v244
    v_and_b32 v245, 1, v246
    v_lshl_add_u32 v245, v245, 2, v249
    s_lshl_b32 s36, s5, 2
    s_xor_b32 s37, s36, 0
    v_xor_b32 v248, s37, v245
    v_lshl_add_u32 v228, v248, 5, v244
    s_xor_b32 s37, s36, 1
    v_xor_b32 v248, s37, v245
    v_lshl_add_u32 v229, v248, 5, v244
    s_xor_b32 s37, s36, 2
    s_add_u32 m0, s50, 28672
    s_nop 0
    buffer_load_dwordx4 v11, s[20:23], s47 offen lds
    v_xor_b32 v248, s37, v245
    v_lshl_add_u32 v230, v248, 5, v244
    s_xor_b32 s37, s36, 3
    v_xor_b32 v248, s37, v245
    v_lshl_add_u32 v231, v248, 5, v244
    s_xor_b32 s37, s36, 4
    v_xor_b32 v248, s37, v245
    v_lshl_add_u32 v232, v248, 5, v244
    s_xor_b32 s37, s36, 5
    v_xor_b32 v248, s37, v245
    v_lshl_add_u32 v233, v248, 5, v244
    s_xor_b32 s37, s36, 6
    v_xor_b32 v248, s37, v245
    v_lshl_add_u32 v234, v248, 5, v244
    s_xor_b32 s37, s36, 7
    v_xor_b32 v248, s37, v245
    v_lshl_add_u32 v235, v248, 5, v244
    s_mul_i32 s34, s3, 10240
    s_add_u32 m0, s49, 32768
    s_nop 0
    buffer_load_dwordx4 v6, s[8:11], s46 offen lds
    s_add_u32 s34, s34, 122880
    v_lshlrev_b32 v244, 4, v2
    v_add_u32 v242, s34, v244
    s_xor_b32 s35, s3, 2
    s_mul_i32 s35, s35, 10240
    s_add_u32 s35, s35, 122880
    v_add_u32 v243, s35, v244
    v_accvgpr_write_b32 a0, 0
    v_accvgpr_write_b32 a1, 0
    v_accvgpr_write_b32 a2, 0
    v_accvgpr_write_b32 a3, 0
    v_accvgpr_write_b32 a4, 0
    v_accvgpr_write_b32 a5, 0
    v_accvgpr_write_b32 a6, 0
    v_accvgpr_write_b32 a7, 0
    v_accvgpr_write_b32 a8, 0
    v_accvgpr_write_b32 a9, 0
    v_accvgpr_write_b32 a10, 0
    s_add_u32 m0, s49, 36864
    s_nop 0
    buffer_load_dwordx4 v7, s[8:11], s46 offen lds
    v_accvgpr_write_b32 a11, 0
    v_accvgpr_write_b32 a12, 0
    v_accvgpr_write_b32 a13, 0
    v_accvgpr_write_b32 a14, 0
    v_accvgpr_write_b32 a15, 0
    v_accvgpr_write_b32 a16, 0
    v_accvgpr_write_b32 a17, 0
    v_accvgpr_write_b32 a18, 0
    v_accvgpr_write_b32 a19, 0
    v_accvgpr_write_b32 a20, 0
    v_accvgpr_write_b32 a21, 0
    v_accvgpr_write_b32 a22, 0
    v_accvgpr_write_b32 a23, 0
    v_accvgpr_write_b32 a24, 0
    v_accvgpr_write_b32 a25, 0
    v_accvgpr_write_b32 a26, 0
    v_accvgpr_write_b32 a27, 0
    v_accvgpr_write_b32 a28, 0
    s_add_u32 s46, s46, 128
    s_add_u32 s47, s47, 0x80000
    s_cmp_eq_u32 s46, s42
    s_cselect_b32 s46, s40, s46
    s_cselect_b32 s47, s41, s47
    s_add_u32 m0, s50, 32768
    s_nop 0
    buffer_load_dwordx4 v8, s[20:23], s47 offen lds
    v_accvgpr_write_b32 a29, 0
    v_accvgpr_write_b32 a30, 0
    v_accvgpr_write_b32 a31, 0
    v_accvgpr_write_b32 a32, 0
    v_accvgpr_write_b32 a33, 0
    v_accvgpr_write_b32 a34, 0
    v_accvgpr_write_b32 a35, 0
    v_accvgpr_write_b32 a36, 0
    v_accvgpr_write_b32 a37, 0
    v_accvgpr_write_b32 a38, 0
    v_accvgpr_write_b32 a39, 0
    v_accvgpr_write_b32 a40, 0
    v_accvgpr_write_b32 a41, 0
    v_accvgpr_write_b32 a42, 0
    v_accvgpr_write_b32 a43, 0
    v_accvgpr_write_b32 a44, 0
    v_accvgpr_write_b32 a45, 0
    v_accvgpr_write_b32 a46, 0
    s_add_u32 m0, s49, 40960
    s_nop 0
    buffer_load_dwordx4 v3, s[8:11], s46 offen lds
    v_accvgpr_write_b32 a47, 0
    v_accvgpr_write_b32 a48, 0
    v_accvgpr_write_b32 a49, 0
    v_accvgpr_write_b32 a50, 0
    v_accvgpr_write_b32 a51, 0
    v_accvgpr_write_b32 a52, 0
    v_accvgpr_write_b32 a53, 0
    v_accvgpr_write_b32 a54, 0
    v_accvgpr_write_b32 a55, 0
    v_accvgpr_write_b32 a56, 0
    v_accvgpr_write_b32 a57, 0
    v_accvgpr_write_b32 a58, 0
    v_accvgpr_write_b32 a59, 0
    v_accvgpr_write_b32 a60, 0
    v_accvgpr_write_b32 a61, 0
    v_accvgpr_write_b32 a62, 0
    v_accvgpr_write_b32 a63, 0
    v_accvgpr_write_b32 a64, 0
    s_add_u32 m0, s50, 36864
    s_nop 0
    buffer_load_dwordx4 v9, s[20:23], s47 offen lds
    v_accvgpr_write_b32 a65, 0
    v_accvgpr_write_b32 a66, 0
    v_accvgpr_write_b32 a67, 0
    v_accvgpr_write_b32 a68, 0
    v_accvgpr_write_b32 a69, 0
    v_accvgpr_write_b32 a70, 0
    v_accvgpr_write_b32 a71, 0
    v_accvgpr_write_b32 a72, 0
    v_accvgpr_write_b32 a73, 0
    v_accvgpr_write_b32 a74, 0
    v_accvgpr_write_b32 a75, 0
    v_accvgpr_write_b32 a76, 0
    v_accvgpr_write_b32 a77, 0
    v_accvgpr_write_b32 a78, 0
    v_accvgpr_write_b32 a79, 0
    v_accvgpr_write_b32 a80, 0
    v_accvgpr_write_b32 a81, 0
    v_accvgpr_write_b32 a82, 0
    s_add_u32 m0, s49, 45056
    s_nop 0
    buffer_load_dwordx4 v4, s[8:11], s46 offen lds
    v_accvgpr_write_b32 a83, 0
    v_accvgpr_write_b32 a84, 0
    v_accvgpr_write_b32 a85, 0
    v_accvgpr_write_b32 a86, 0
    v_accvgpr_write_b32 a87, 0
    v_accvgpr_write_b32 a88, 0
    v_accvgpr_write_b32 a89, 0
    v_accvgpr_write_b32 a90, 0
    v_accvgpr_write_b32 a91, 0
    v_accvgpr_write_b32 a92, 0
    v_accvgpr_write_b32 a93, 0
    v_accvgpr_write_b32 a94, 0
    v_accvgpr_write_b32 a95, 0
    v_accvgpr_write_b32 a96, 0
    v_accvgpr_write_b32 a97, 0
    v_accvgpr_write_b32 a98, 0
    v_accvgpr_write_b32 a99, 0
    v_accvgpr_write_b32 a196, 0
    s_add_u32 m0, s50, 40960
    s_nop 0
    buffer_load_dwordx4 v10, s[20:23], s47 offen lds
    v_accvgpr_write_b32 a197, 0
    v_accvgpr_write_b32 a198, 0
    v_accvgpr_write_b32 a199, 0
    v_accvgpr_write_b32 a200, 0
    v_accvgpr_write_b32 a201, 0
    v_accvgpr_write_b32 a202, 0
    v_accvgpr_write_b32 a203, 0
    v_accvgpr_write_b32 a204, 0
    v_accvgpr_write_b32 a205, 0
    v_accvgpr_write_b32 a206, 0
    v_accvgpr_write_b32 a207, 0
    v_accvgpr_write_b32 a208, 0
    v_accvgpr_write_b32 a209, 0
    v_accvgpr_write_b32 a210, 0
    v_accvgpr_write_b32 a211, 0
    v_accvgpr_write_b32 a212, 0
    v_accvgpr_write_b32 a213, 0
    v_accvgpr_write_b32 a214, 0
    s_add_u32 m0, s49, 49152
    s_nop 0
    buffer_load_dwordx4 v5, s[8:11], s46 offen lds
    v_accvgpr_write_b32 a215, 0
    v_accvgpr_write_b32 a216, 0
    v_accvgpr_write_b32 a217, 0
    v_accvgpr_write_b32 a218, 0
    v_accvgpr_write_b32 a219, 0
    v_accvgpr_write_b32 a220, 0
    v_accvgpr_write_b32 a221, 0
    v_accvgpr_write_b32 a222, 0
    v_accvgpr_write_b32 a223, 0
    v_accvgpr_write_b32 a224, 0
    v_accvgpr_write_b32 a225, 0
    v_accvgpr_write_b32 a226, 0
    v_accvgpr_write_b32 a227, 0
    v_mov_b32 v196, 0
    v_mov_b32 v197, 0
    v_mov_b32 v198, 0
    v_mov_b32 v199, 0
    v_mov_b32 v220, 0x3f803f80
    s_add_u32 m0, s50, 45056
    s_nop 0
    buffer_load_dwordx4 v11, s[20:23], s47 offen lds
    v_mov_b32 v221, 0x3f803f80
    v_mov_b32 v222, 0x3f803f80
    v_mov_b32 v223, 0x3f803f80
    v_mov_b32 v200, 0
    v_mov_b32 v201, 0
    v_mov_b32 v202, 0
    v_mov_b32 v203, 0
    v_mov_b32 v204, 0
    v_mov_b32 v205, 0
    v_mov_b32 v206, 0
    v_mov_b32 v207, 0
    v_mov_b32 v208, 0
    v_mov_b32 v209, 0
    v_mov_b32 v210, 0
    v_mov_b32 v211, 0
    v_mov_b32 v212, 0
    v_mov_b32 v213, 0
    v_mov_b32 v214, 0
    s_add_u32 m0, s49, 53248
    s_nop 0
    buffer_load_dwordx4 v6, s[8:11], s46 offen lds
    v_mov_b32 v215, 0
    v_mov_b32 v216, 0
    v_mov_b32 v217, 0
    v_mov_b32 v218, 0
    v_mov_b32 v219, 0
    s_add_u32 m0, s49, 57344
    s_nop 0
    buffer_load_dwordx4 v7, s[8:11], s46 offen lds
    v_mov_b32 v254, 0x7f000000
    v_cmp_gt_u32 vcc, 24, v2
    s_nop 1
    v_cndmask_b32 v254, v254, v255, vcc
    buffer_load_dwordx4 a[228:231], v255, s[52:55], s51 offen offset:0
    buffer_load_dwordx4 a[232:235], v255, s[52:55], s51 offen offset:1024
    buffer_load_dwordx4 a[236:239], v255, s[52:55], s51 offen offset:2048
    buffer_load_dwordx4 a[240:243], v254, s[52:55], s51 offen offset:3072
    s_waitcnt vmcnt(22)
    s_barrier
    ds_read_b64_tr_b16 a[100:101], v14 offset:0
    ds_read_b64_tr_b16 a[102:103], v14 offset:1024
    ds_read_b128 a[132:135], v12 offset:0
    ds_read_b128 a[136:139], v12 offset:2048
    ds_read_b128 a[140:143], v12 offset:4096
    ds_read_b128 a[144:147], v12 offset:6144
    ds_read_b128 a[148:151], v12 offset:8192
    ds_read_b64_tr_b16 a[104:105], v14 offset:8
    ds_read_b64_tr_b16 a[106:107], v14 offset:1032
    ds_read_b64_tr_b16 a[108:109], v15 offset:0
    ds_read_b64_tr_b16 a[110:111], v15 offset:1024
    ds_read_b64_tr_b16 a[112:113], v15 offset:8
    ds_read_b64_tr_b16 a[114:115], v15 offset:1032
    s_waitcnt lgkmcnt(0)
    v_mfma_f32_16x16x32_bf16 v[96:99], a[100:103], a[132:135], 0
    ds_read_b64_tr_b16 a[116:117], v14 offset:8192
    ds_read_b64_tr_b16 a[118:119], v14 offset:9216
    v_mfma_f32_16x16x32_bf16 v[112:115], a[100:103], a[136:139], 0
    ds_read_b128 a[152:155], v13 offset:0
    ds_read_b128 a[156:159], v13 offset:2048
    v_mfma_f32_16x16x32_bf16 v[128:131], a[100:103], a[140:143], 0
    ds_read_b128 a[160:163], v13 offset:4096
    ds_read_b128 a[164:167], v13 offset:6144
    v_mfma_f32_16x16x32_bf16 v[144:147], a[100:103], a[144:147], 0
    ds_read_b128 a[168:171], v13 offset:8192
    ds_read_b64_tr_b16 a[120:121], v14 offset:8200
    v_mfma_f32_16x16x32_bf16 v[160:163], a[100:103], a[148:151], 0
    ds_read_b64_tr_b16 a[122:123], v14 offset:9224
    ds_read_b64_tr_b16 a[124:125], v15 offset:8192
    v_mfma_f32_16x16x32_bf16 v[100:103], a[104:107], a[132:135], 0
    ds_read_b64_tr_b16 a[126:127], v15 offset:9216
    ds_read_b64_tr_b16 a[128:129], v15 offset:8200
    v_mfma_f32_16x16x32_bf16 v[116:119], a[104:107], a[136:139], 0
    ds_read_b64_tr_b16 a[130:131], v15 offset:9224
    v_mfma_f32_16x16x32_bf16 v[132:135], a[104:107], a[140:143], 0
    v_mfma_f32_16x16x32_bf16 v[148:151], a[104:107], a[144:147], 0
    v_mfma_f32_16x16x32_bf16 v[164:167], a[104:107], a[148:151], 0
    v_mfma_f32_16x16x32_bf16 v[104:107], a[108:111], a[132:135], 0
    v_mfma_f32_16x16x32_bf16 v[120:123], a[108:111], a[136:139], 0
    v_mfma_f32_16x16x32_bf16 v[136:139], a[108:111], a[140:143], 0
    v_mfma_f32_16x16x32_bf16 v[152:155], a[108:111], a[144:147], 0
    v_mfma_f32_16x16x32_bf16 v[168:171], a[108:111], a[148:151], 0
    v_mfma_f32_16x16x32_bf16 v[108:111], a[112:115], a[132:135], 0
    v_mfma_f32_16x16x32_bf16 v[124:127], a[112:115], a[136:139], 0
    v_mfma_f32_16x16x32_bf16 v[140:143], a[112:115], a[140:143], 0
    v_mfma_f32_16x16x32_bf16 v[156:159], a[112:115], a[144:147], 0
    v_mfma_f32_16x16x32_bf16 v[172:175], a[112:115], a[148:151], 0
    s_waitcnt vmcnt(13) lgkmcnt(0)
    s_barrier
    v_mfma_f32_16x16x32_bf16 v[96:99], a[116:119], a[152:155], v[96:99]
    ds_read_b64_tr_b16 a[100:101], v14 offset:16384
    ds_read_b64_tr_b16 a[102:103], v14 offset:17408
    v_mfma_f32_16x16x32_bf16 v[112:115], a[116:119], a[156:159], v[112:115]
    ds_read_b128 a[132:135], v12 offset:20480
    ds_read_b128 a[136:139], v12 offset:22528
    v_mfma_f32_16x16x32_bf16 v[128:131], a[116:119], a[160:163], v[128:131]
    ds_read_b128 a[140:143], v12 offset:24576
    ds_read_b128 a[144:147], v12 offset:26624
    v_mfma_f32_16x16x32_bf16 v[144:147], a[116:119], a[164:167], v[144:147]
    ds_read_b128 a[148:151], v12 offset:28672
    ds_read_b64_tr_b16 a[104:105], v14 offset:16392
    v_mfma_f32_16x16x32_bf16 v[160:163], a[116:119], a[168:171], v[160:163]
    ds_read_b64_tr_b16 a[106:107], v14 offset:17416
    ds_read_b64_tr_b16 a[108:109], v15 offset:16384
    v_mfma_f32_16x16x32_bf16 v[100:103], a[120:123], a[152:155], v[100:103]
    ds_read_b64_tr_b16 a[110:111], v15 offset:17408
    ds_read_b64_tr_b16 a[112:113], v15 offset:16392
    v_mfma_f32_16x16x32_bf16 v[116:119], a[120:123], a[156:159], v[116:119]
    ds_read_b64_tr_b16 a[114:115], v15 offset:17416
    v_mfma_f32_16x16x32_bf16 v[132:135], a[120:123], a[160:163], v[132:135]
    s_add_u32 s46, s46, 128
    s_add_u32 s47, s47, 0x80000
    s_cmp_eq_u32 s46, s42
    s_cselect_b32 s46, s40, s46
    s_cselect_b32 s47, s41, s47
    s_add_u32 m0, s50, 0
    v_mfma_f32_16x16x32_bf16 v[148:151], a[120:123], a[164:167], v[148:151]
    buffer_load_dwordx4 v8, s[20:23], s47 offen lds
    v_mfma_f32_16x16x32_bf16 v[164:167], a[120:123], a[168:171], v[164:167]
    s_add_u32 m0, s49, 0
    v_mfma_f32_16x16x32_bf16 v[104:107], a[124:127], a[152:155], v[104:107]
    buffer_load_dwordx4 v3, s[8:11], s46 offen lds
    v_mfma_f32_16x16x32_bf16 v[120:123], a[124:127], a[156:159], v[120:123]
    s_add_u32 m0, s50, 4096
    v_mfma_f32_16x16x32_bf16 v[136:139], a[124:127], a[160:163], v[136:139]
    buffer_load_dwordx4 v9, s[20:23], s47 offen lds
    v_mfma_f32_16x16x32_bf16 v[152:155], a[124:127], a[164:167], v[152:155]
    s_add_u32 m0, s49, 4096
    v_mfma_f32_16x16x32_bf16 v[168:171], a[124:127], a[168:171], v[168:171]
    buffer_load_dwordx4 v4, s[8:11], s46 offen lds
    v_mfma_f32_16x16x32_bf16 v[108:111], a[128:131], a[152:155], v[108:111]
    s_add_u32 m0, s50, 8192
    v_mfma_f32_16x16x32_bf16 v[124:127], a[128:131], a[156:159], v[124:127]
    buffer_load_dwordx4 v10, s[20:23], s47 offen lds
    v_mfma_f32_16x16x32_bf16 v[140:143], a[128:131], a[160:163], v[140:143]
    s_add_u32 m0, s49, 8192
    v_mfma_f32_16x16x32_bf16 v[156:159], a[128:131], a[164:167], v[156:159]
    buffer_load_dwordx4 v5, s[8:11], s46 offen lds
    v_mfma_f32_16x16x32_bf16 v[172:175], a[128:131], a[168:171], v[172:175]
    s_waitcnt lgkmcnt(0)
    v_mfma_f32_16x16x32_bf16 v[96:99], a[100:103], a[132:135], v[96:99]
    ds_read_b64_tr_b16 a[116:117], v14 offset:24576
    ds_read_b64_tr_b16 a[118:119], v14 offset:25600
    v_mfma_f32_16x16x32_bf16 v[112:115], a[100:103], a[136:139], v[112:115]
    ds_read_b128 a[152:155], v13 offset:20480
    ds_read_b128 a[156:159], v13 offset:22528
    v_mfma_f32_16x16x32_bf16 v[128:131], a[100:103], a[140:143], v[128:131]
    ds_read_b128 a[160:163], v13 offset:24576
    ds_read_b128 a[164:167], v13 offset:26624
    v_mfma_f32_16x16x32_bf16 v[144:147], a[100:103], a[144:147], v[144:147]
    ds_read_b128 a[168:171], v13 offset:28672
    ds_read_b64_tr_b16 a[120:121], v14 offset:24584
    v_mfma_f32_16x16x32_bf16 v[160:163], a[100:103], a[148:151], v[160:163]
    ds_read_b64_tr_b16 a[122:123], v14 offset:25608
    ds_read_b64_tr_b16 a[124:125], v15 offset:24576
    v_mfma_f32_16x16x32_bf16 v[100:103], a[104:107], a[132:135], v[100:103]
    ds_read_b64_tr_b16 a[126:127], v15 offset:25600
    ds_read_b64_tr_b16 a[128:129], v15 offset:24584
    v_mfma_f32_16x16x32_bf16 v[116:119], a[104:107], a[136:139], v[116:119]
    ds_read_b64_tr_b16 a[130:131], v15 offset:25608
    v_mfma_f32_16x16x32_bf16 v[132:135], a[104:107], a[140:143], v[132:135]
    s_add_u32 m0, s50, 12288
    v_mfma_f32_16x16x32_bf16 v[148:151], a[104:107], a[144:147], v[148:151]
    buffer_load_dwordx4 v11, s[20:23], s47 offen lds
    v_mfma_f32_16x16x32_bf16 v[164:167], a[104:107], a[148:151], v[164:167]
    s_add_u32 m0, s49, 12288
    v_mfma_f32_16x16x32_bf16 v[104:107], a[108:111], a[132:135], v[104:107]
    buffer_load_dwordx4 v6, s[8:11], s46 offen lds
    v_mfma_f32_16x16x32_bf16 v[120:123], a[108:111], a[136:139], v[120:123]
    s_add_u32 m0, s49, 16384
    v_mfma_f32_16x16x32_bf16 v[136:139], a[108:111], a[140:143], v[136:139]
    buffer_load_dwordx4 v7, s[8:11], s46 offen lds
    v_mfma_f32_16x16x32_bf16 v[152:155], a[108:111], a[144:147], v[152:155]
    v_mfma_f32_16x16x32_bf16 v[168:171], a[108:111], a[148:151], v[168:171]
    v_mfma_f32_16x16x32_bf16 v[108:111], a[112:115], a[132:135], v[108:111]
    v_mfma_f32_16x16x32_bf16 v[124:127], a[112:115], a[136:139], v[124:127]
    v_mfma_f32_16x16x32_bf16 v[140:143], a[112:115], a[140:143], v[140:143]
    v_mfma_f32_16x16x32_bf16 v[156:159], a[112:115], a[144:147], v[156:159]
    v_mfma_f32_16x16x32_bf16 v[172:175], a[112:115], a[148:151], v[172:175]
    s_waitcnt vmcnt(13) lgkmcnt(0)
    s_barrier
    v_mfma_f32_16x16x32_bf16 v[96:99], a[116:119], a[152:155], v[96:99]
    ds_read_b64_tr_b16 a[100:101], v14 offset:32768
    ds_read_b64_tr_b16 a[102:103], v14 offset:33792
    v_mfma_f32_16x16x32_bf16 v[112:115], a[116:119], a[156:159], v[112:115]
    ds_read_b128 a[132:135], v12 offset:40960
    ds_read_b128 a[136:139], v12 offset:43008
    v_mfma_f32_16x16x32_bf16 v[128:131], a[116:119], a[160:163], v[128:131]
    ds_read_b128 a[140:143], v12 offset:45056
    ds_read_b128 a[144:147], v12 offset:47104
    v_mfma_f32_16x16x32_bf16 v[144:147], a[116:119], a[164:167], v[144:147]
    ds_read_b128 a[148:151], v12 offset:49152
    ds_read_b64_tr_b16 a[104:105], v14 offset:32776
    v_mfma_f32_16x16x32_bf16 v[160:163], a[116:119], a[168:171], v[160:163]
    ds_read_b64_tr_b16 a[106:107], v14 offset:33800
    ds_read_b64_tr_b16 a[108:109], v15 offset:32768
    v_mfma_f32_16x16x32_bf16 v[100:103], a[120:123], a[152:155], v[100:103]
    ds_read_b64_tr_b16 a[110:111], v15 offset:33792
    ds_read_b64_tr_b16 a[112:113], v15 offset:32776
    v_mfma_f32_16x16x32_bf16 v[116:119], a[120:123], a[156:159], v[116:119]
    ds_read_b64_tr_b16 a[114:115], v15 offset:33800
    v_mfma_f32_16x16x32_bf16 v[132:135], a[120:123], a[160:163], v[132:135]
    s_add_u32 s46, s46, 128
    s_add_u32 s47, s47, 0x80000
    s_cmp_eq_u32 s46, s42
    s_cselect_b32 s46, s40, s46
    s_cselect_b32 s47, s41, s47
    s_add_u32 m0, s50, 16384
    v_mfma_f32_16x16x32_bf16 v[148:151], a[120:123], a[164:167], v[148:151]
    buffer_load_dwordx4 v8, s[20:23], s47 offen lds
    v_mfma_f32_16x16x32_bf16 v[164:167], a[120:123], a[168:171], v[164:167]
    s_add_u32 m0, s49, 20480
    v_mfma_f32_16x16x32_bf16 v[104:107], a[124:127], a[152:155], v[104:107]
    buffer_load_dwordx4 v3, s[8:11], s46 offen lds
    v_mfma_f32_16x16x32_bf16 v[120:123], a[124:127], a[156:159], v[120:123]
    s_add_u32 m0, s50, 20480
    v_mfma_f32_16x16x32_bf16 v[136:139], a[124:127], a[160:163], v[136:139]
    buffer_load_dwordx4 v9, s[20:23], s47 offen lds
    v_mfma_f32_16x16x32_bf16 v[152:155], a[124:127], a[164:167], v[152:155]
    s_add_u32 m0, s49, 24576
    v_mfma_f32_16x16x32_bf16 v[168:171], a[124:127], a[168:171], v[168:171]
    buffer_load_dwordx4 v4, s[8:11], s46 offen lds
    v_mfma_f32_16x16x32_bf16 v[108:111], a[128:131], a[152:155], v[108:111]
    s_add_u32 m0, s50, 24576
    v_mfma_f32_16x16x32_bf16 v[124:127], a[128:131], a[156:159], v[124:127]
    buffer_load_dwordx4 v10, s[20:23], s47 offen lds
    v_mfma_f32_16x16x32_bf16 v[140:143], a[128:131], a[160:163], v[140:143]
    s_add_u32 m0, s49, 28672
    v_mfma_f32_16x16x32_bf16 v[156:159], a[128:131], a[164:167], v[156:159]
    buffer_load_dwordx4 v5, s[8:11], s46 offen lds
    v_mfma_f32_16x16x32_bf16 v[172:175], a[128:131], a[168:171], v[172:175]
    s_waitcnt lgkmcnt(0)
    v_mfma_f32_16x16x32_bf16 v[96:99], a[100:103], a[132:135], v[96:99]
    ds_read_b64_tr_b16 a[116:117], v14 offset:40960
    ds_read_b64_tr_b16 a[118:119], v14 offset:41984
    v_mfma_f32_16x16x32_bf16 v[112:115], a[100:103], a[136:139], v[112:115]
    ds_read_b128 a[152:155], v13 offset:40960
    ds_read_b128 a[156:159], v13 offset:43008
    v_mfma_f32_16x16x32_bf16 v[128:131], a[100:103], a[140:143], v[128:131]
    ds_read_b128 a[160:163], v13 offset:45056
    ds_read_b128 a[164:167], v13 offset:47104
    v_mfma_f32_16x16x32_bf16 v[144:147], a[100:103], a[144:147], v[144:147]
    ds_read_b128 a[168:171], v13 offset:49152
    ds_read_b64_tr_b16 a[120:121], v14 offset:40968
    v_mfma_f32_16x16x32_bf16 v[160:163], a[100:103], a[148:151], v[160:163]
    ds_read_b64_tr_b16 a[122:123], v14 offset:41992
    ds_read_b64_tr_b16 a[124:125], v15 offset:40960
    v_mfma_f32_16x16x32_bf16 v[100:103], a[104:107], a[132:135], v[100:103]
    ds_read_b64_tr_b16 a[126:127], v15 offset:41984
    ds_read_b64_tr_b16 a[128:129], v15 offset:40968
    v_mfma_f32_16x16x32_bf16 v[116:119], a[104:107], a[136:139], v[116:119]
    ds_read_b64_tr_b16 a[130:131], v15 offset:41992
    v_mfma_f32_16x16x32_bf16 v[132:135], a[104:107], a[140:143], v[132:135]
    s_add_u32 m0, s50, 28672
    v_mfma_f32_16x16x32_bf16 v[148:151], a[104:107], a[144:147], v[148:151]
    buffer_load_dwordx4 v11, s[20:23], s47 offen lds
    v_mfma_f32_16x16x32_bf16 v[164:167], a[104:107], a[148:151], v[164:167]
    s_add_u32 m0, s49, 32768
    v_mfma_f32_16x16x32_bf16 v[104:107], a[108:111], a[132:135], v[104:107]
    buffer_load_dwordx4 v6, s[8:11], s46 offen lds
    v_mfma_f32_16x16x32_bf16 v[120:123], a[108:111], a[136:139], v[120:123]
    s_add_u32 m0, s49, 36864
    v_mfma_f32_16x16x32_bf16 v[136:139], a[108:111], a[140:143], v[136:139]
    buffer_load_dwordx4 v7, s[8:11], s46 offen lds
    v_mfma_f32_16x16x32_bf16 v[152:155], a[108:111], a[144:147], v[152:155]
    v_mfma_f32_16x16x32_bf16 v[168:171], a[108:111], a[148:151], v[168:171]
    v_mfma_f32_16x16x32_bf16 v[108:111], a[112:115], a[132:135], v[108:111]
    v_mfma_f32_16x16x32_bf16 v[124:127], a[112:115], a[136:139], v[124:127]
    v_mfma_f32_16x16x32_bf16 v[140:143], a[112:115], a[140:143], v[140:143]
    v_mfma_f32_16x16x32_bf16 v[156:159], a[112:115], a[144:147], v[156:159]
    v_mfma_f32_16x16x32_bf16 v[172:175], a[112:115], a[148:151], v[172:175]
    s_waitcnt vmcnt(9) lgkmcnt(0)
    s_barrier
    v_mfma_f32_16x16x32_bf16 v[96:99], a[116:119], a[152:155], v[96:99]
    ds_read_b64_tr_b16 a[100:101], v14 offset:0
    ds_read_b64_tr_b16 a[102:103], v14 offset:1024
    v_mfma_f32_16x16x32_bf16 v[112:115], a[116:119], a[156:159], v[112:115]
    ds_read_b128 a[132:135], v12 offset:0
    ds_read_b128 a[136:139], v12 offset:2048
    v_mfma_f32_16x16x32_bf16 v[128:131], a[116:119], a[160:163], v[128:131]
    ds_read_b128 a[140:143], v12 offset:4096
    ds_read_b128 a[144:147], v12 offset:6144
    v_mfma_f32_16x16x32_bf16 v[144:147], a[116:119], a[164:167], v[144:147]
    ds_read_b128 a[148:151], v12 offset:8192
    ds_read_b64_tr_b16 a[104:105], v14 offset:8
    v_mfma_f32_16x16x32_bf16 v[160:163], a[116:119], a[168:171], v[160:163]
    ds_read_b64_tr_b16 a[106:107], v14 offset:1032
    ds_read_b64_tr_b16 a[108:109], v15 offset:0
    v_mfma_f32_16x16x32_bf16 v[100:103], a[120:123], a[152:155], v[100:103]
    ds_read_b64_tr_b16 a[110:111], v15 offset:1024
    ds_read_b64_tr_b16 a[112:113], v15 offset:8
    v_mfma_f32_16x16x32_bf16 v[116:119], a[120:123], a[156:159], v[116:119]
    ds_read_b64_tr_b16 a[114:115], v15 offset:1032
    v_mfma_f32_16x16x32_bf16 v[132:135], a[120:123], a[160:163], v[132:135]
    s_add_u32 s46, s46, 128
    s_add_u32 s47, s47, 0x80000
    s_cmp_eq_u32 s46, s42
    s_cselect_b32 s46, s40, s46
    s_cselect_b32 s47, s41, s47
    s_add_u32 m0, s50, 32768
    v_mfma_f32_16x16x32_bf16 v[148:151], a[120:123], a[164:167], v[148:151]
    buffer_load_dwordx4 v8, s[20:23], s47 offen lds
    v_mfma_f32_16x16x32_bf16 v[164:167], a[120:123], a[168:171], v[164:167]
    s_add_u32 m0, s49, 40960
    v_mfma_f32_16x16x32_bf16 v[104:107], a[124:127], a[152:155], v[104:107]
    buffer_load_dwordx4 v3, s[8:11], s46 offen lds
    v_mfma_f32_16x16x32_bf16 v[120:123], a[124:127], a[156:159], v[120:123]
    s_add_u32 m0, s50, 36864
    v_mfma_f32_16x16x32_bf16 v[136:139], a[124:127], a[160:163], v[136:139]
    buffer_load_dwordx4 v9, s[20:23], s47 offen lds
    v_mfma_f32_16x16x32_bf16 v[152:155], a[124:127], a[164:167], v[152:155]
    s_add_u32 m0, s49, 45056
    v_mfma_f32_16x16x32_bf16 v[168:171], a[124:127], a[168:171], v[168:171]
    buffer_load_dwordx4 v4, s[8:11], s46 offen lds
    v_mfma_f32_16x16x32_bf16 v[108:111], a[128:131], a[152:155], v[108:111]
    s_add_u32 m0, s50, 40960
    v_mfma_f32_16x16x32_bf16 v[124:127], a[128:131], a[156:159], v[124:127]
    buffer_load_dwordx4 v10, s[20:23], s47 offen lds
    v_mfma_f32_16x16x32_bf16 v[140:143], a[128:131], a[160:163], v[140:143]
    s_add_u32 m0, s49, 49152
    v_mfma_f32_16x16x32_bf16 v[156:159], a[128:131], a[164:167], v[156:159]
    buffer_load_dwordx4 v5, s[8:11], s46 offen lds
    v_mfma_f32_16x16x32_bf16 v[172:175], a[128:131], a[168:171], v[172:175]
    s_waitcnt lgkmcnt(0)
    v_mfma_f32_16x16x32_bf16 v[96:99], a[100:103], a[132:135], v[96:99]
    ds_read_b64_tr_b16 a[116:117], v14 offset:8192
    ds_read_b64_tr_b16 a[118:119], v14 offset:9216
    v_mfma_f32_16x16x32_bf16 v[112:115], a[100:103], a[136:139], v[112:115]
    ds_read_b128 a[152:155], v13 offset:0
    ds_read_b128 a[156:159], v13 offset:2048
    v_mfma_f32_16x16x32_bf16 v[128:131], a[100:103], a[140:143], v[128:131]
    ds_read_b128 a[160:163], v13 offset:4096
    ds_read_b128 a[164:167], v13 offset:6144
    v_mfma_f32_16x16x32_bf16 v[144:147], a[100:103], a[144:147], v[144:147]
    ds_read_b128 a[168:171], v13 offset:8192
    ds_read_b64_tr_b16 a[120:121], v14 offset:8200
    v_mfma_f32_16x16x32_bf16 v[160:163], a[100:103], a[148:151], v[160:163]
    ds_read_b64_tr_b16 a[122:123], v14 offset:9224
    ds_read_b64_tr_b16 a[124:125], v15 offset:8192
    v_mfma_f32_16x16x32_bf16 v[100:103], a[104:107], a[132:135], v[100:103]
    ds_read_b64_tr_b16 a[126:127], v15 offset:9216
    ds_read_b64_tr_b16 a[128:129], v15 offset:8200
    v_mfma_f32_16x16x32_bf16 v[116:119], a[104:107], a[136:139], v[116:119]
    ds_read_b64_tr_b16 a[130:131], v15 offset:9224
    v_mfma_f32_16x16x32_bf16 v[132:135], a[104:107], a[140:143], v[132:135]
    s_add_u32 m0, s50, 45056
    v_mfma_f32_16x16x32_bf16 v[148:151], a[104:107], a[144:147], v[148:151]
    buffer_load_dwordx4 v11, s[20:23], s47 offen lds
    v_mfma_f32_16x16x32_bf16 v[164:167], a[104:107], a[148:151], v[164:167]
    s_add_u32 m0, s49, 53248
    v_mfma_f32_16x16x32_bf16 v[104:107], a[108:111], a[132:135], v[104:107]
    buffer_load_dwordx4 v6, s[8:11], s46 offen lds
    v_mfma_f32_16x16x32_bf16 v[120:123], a[108:111], a[136:139], v[120:123]
    s_add_u32 m0, s49, 57344
    v_mfma_f32_16x16x32_bf16 v[136:139], a[108:111], a[140:143], v[136:139]
    buffer_load_dwordx4 v7, s[8:11], s46 offen lds
    v_mfma_f32_16x16x32_bf16 v[152:155], a[108:111], a[144:147], v[152:155]
    s_mov_b32 s30, s48
    s_add_u32 m0, s31, 0
    v_mfma_f32_16x16x32_bf16 v[168:171], a[108:111], a[148:151], v[168:171]
    buffer_load_dwordx4 v236, s[12:15], s30 offen offset:0 nt lds
    v_mfma_f32_16x16x32_bf16 v[108:111], a[112:115], a[132:135], v[108:111]
    v_mfma_f32_16x16x32_bf16 v[124:127], a[112:115], a[136:139], v[124:127]
    buffer_load_dwordx4 v237, s[12:15], s30 offen offset:1024 nt lds
    v_mfma_f32_16x16x32_bf16 v[140:143], a[112:115], a[140:143], v[140:143]
    v_mfma_f32_16x16x32_bf16 v[156:159], a[112:115], a[144:147], v[156:159]
    buffer_load_dwordx4 v238, s[12:15], s30 offen offset:2048 nt lds
    v_mfma_f32_16x16x32_bf16 v[172:175], a[112:115], a[148:151], v[172:175]
    s_waitcnt vmcnt(12) lgkmcnt(0)
    s_barrier
    v_mfma_f32_16x16x32_bf16 v[96:99], a[116:119], a[152:155], v[96:99]
    ds_read_b64_tr_b16 a[100:101], v14 offset:16384
    ds_read_b64_tr_b16 a[102:103], v14 offset:17408
    v_mfma_f32_16x16x32_bf16 v[112:115], a[116:119], a[156:159], v[112:115]
    ds_read_b128 a[132:135], v12 offset:20480
    ds_read_b128 a[136:139], v12 offset:22528
    v_mfma_f32_16x16x32_bf16 v[128:131], a[116:119], a[160:163], v[128:131]
    ds_read_b128 a[140:143], v12 offset:24576
    ds_read_b128 a[144:147], v12 offset:26624
    v_mfma_f32_16x16x32_bf16 v[144:147], a[116:119], a[164:167], v[144:147]
    ds_read_b128 a[148:151], v12 offset:28672
    ds_read_b64_tr_b16 a[104:105], v14 offset:16392
    v_mfma_f32_16x16x32_bf16 v[160:163], a[116:119], a[168:171], v[160:163]
    ds_read_b64_tr_b16 a[106:107], v14 offset:17416
    ds_read_b64_tr_b16 a[108:109], v15 offset:16384
    v_mfma_f32_16x16x32_bf16 v[100:103], a[120:123], a[152:155], v[100:103]
    ds_read_b64_tr_b16 a[110:111], v15 offset:17408
    ds_read_b64_tr_b16 a[112:113], v15 offset:16392
    v_mfma_f32_16x16x32_bf16 v[116:119], a[120:123], a[156:159], v[116:119]
    ds_read_b64_tr_b16 a[114:115], v15 offset:17416
    v_mfma_f32_16x16x32_bf16 v[132:135], a[120:123], a[160:163], v[132:135]
    s_add_u32 s46, s46, 128
    s_add_u32 s47, s47, 0x80000
    s_cmp_eq_u32 s46, s42
    s_cselect_b32 s46, s40, s46
    s_cselect_b32 s47, s41, s47
    s_add_u32 m0, s50, 0
    v_mfma_f32_16x16x32_bf16 v[148:151], a[120:123], a[164:167], v[148:151]
    buffer_load_dwordx4 v8, s[20:23], s47 offen lds
    v_mfma_f32_16x16x32_bf16 v[164:167], a[120:123], a[168:171], v[164:167]
    s_add_u32 m0, s49, 0
    v_mfma_f32_16x16x32_bf16 v[104:107], a[124:127], a[152:155], v[104:107]
    buffer_load_dwordx4 v3, s[8:11], s46 offen lds
    v_mfma_f32_16x16x32_bf16 v[120:123], a[124:127], a[156:159], v[120:123]
    s_add_u32 m0, s50, 4096
    v_mfma_f32_16x16x32_bf16 v[136:139], a[124:127], a[160:163], v[136:139]
    buffer_load_dwordx4 v9, s[20:23], s47 offen lds
    v_mfma_f32_16x16x32_bf16 v[152:155], a[124:127], a[164:167], v[152:155]
    s_add_u32 m0, s49, 4096
    v_mfma_f32_16x16x32_bf16 v[168:171], a[124:127], a[168:171], v[168:171]
    buffer_load_dwordx4 v4, s[8:11], s46 offen lds
    v_mfma_f32_16x16x32_bf16 v[108:111], a[128:131], a[152:155], v[108:111]
    s_add_u32 m0, s50, 8192
    v_mfma_f32_16x16x32_bf16 v[124:127], a[128:131], a[156:159], v[124:127]
    buffer_load_dwordx4 v10, s[20:23], s47 offen lds
    v_mfma_f32_16x16x32_bf16 v[140:143], a[128:131], a[160:163], v[140:143]
    s_add_u32 m0, s49, 8192
    v_mfma_f32_16x16x32_bf16 v[156:159], a[128:131], a[164:167], v[156:159]
    buffer_load_dwordx4 v5, s[8:11], s46 offen lds
    v_mfma_f32_16x16x32_bf16 v[172:175], a[128:131], a[168:171], v[172:175]
    s_waitcnt lgkmcnt(0)
    v_mfma_f32_16x16x32_bf16 v[96:99], a[100:103], a[132:135], v[96:99]
    ds_read_b64_tr_b16 a[116:117], v14 offset:24576
    ds_read_b64_tr_b16 a[118:119], v14 offset:25600
    v_mfma_f32_16x16x32_bf16 v[112:115], a[100:103], a[136:139], v[112:115]
    ds_read_b128 a[152:155], v13 offset:20480
    ds_read_b128 a[156:159], v13 offset:22528
    v_mfma_f32_16x16x32_bf16 v[128:131], a[100:103], a[140:143], v[128:131]
    ds_read_b128 a[160:163], v13 offset:24576
    ds_read_b128 a[164:167], v13 offset:26624
    v_mfma_f32_16x16x32_bf16 v[144:147], a[100:103], a[144:147], v[144:147]
    ds_read_b128 a[168:171], v13 offset:28672
    ds_read_b64_tr_b16 a[120:121], v14 offset:24584
    v_mfma_f32_16x16x32_bf16 v[160:163], a[100:103], a[148:151], v[160:163]
    ds_read_b64_tr_b16 a[122:123], v14 offset:25608
    ds_read_b64_tr_b16 a[124:125], v15 offset:24576
    v_mfma_f32_16x16x32_bf16 v[100:103], a[104:107], a[132:135], v[100:103]
    ds_read_b64_tr_b16 a[126:127], v15 offset:25600
    ds_read_b64_tr_b16 a[128:129], v15 offset:24584
    v_mfma_f32_16x16x32_bf16 v[116:119], a[104:107], a[136:139], v[116:119]
    ds_read_b64_tr_b16 a[130:131], v15 offset:25608
    v_mfma_f32_16x16x32_bf16 v[132:135], a[104:107], a[140:143], v[132:135]
    s_add_u32 m0, s50, 12288
    v_mfma_f32_16x16x32_bf16 v[148:151], a[104:107], a[144:147], v[148:151]
    buffer_load_dwordx4 v11, s[20:23], s47 offen lds
    v_mfma_f32_16x16x32_bf16 v[164:167], a[104:107], a[148:151], v[164:167]
    s_add_u32 m0, s49, 12288
    v_mfma_f32_16x16x32_bf16 v[104:107], a[108:111], a[132:135], v[104:107]
    buffer_load_dwordx4 v6, s[8:11], s46 offen lds
    v_mfma_f32_16x16x32_bf16 v[120:123], a[108:111], a[136:139], v[120:123]
    s_add_u32 m0, s49, 16384
    v_mfma_f32_16x16x32_bf16 v[136:139], a[108:111], a[140:143], v[136:139]
    buffer_load_dwordx4 v7, s[8:11], s46 offen lds
    v_mfma_f32_16x16x32_bf16 v[152:155], a[108:111], a[144:147], v[152:155]
    s_add_u32 m0, s31, 0
    v_mfma_f32_16x16x32_bf16 v[168:171], a[108:111], a[148:151], v[168:171]
    buffer_load_dwordx4 v239, s[12:15], s30 offen offset:3072 nt lds
    v_mfma_f32_16x16x32_bf16 v[108:111], a[112:115], a[132:135], v[108:111]
    s_add_u32 m0, s31, 8192
    v_mfma_f32_16x16x32_bf16 v[124:127], a[112:115], a[136:139], v[124:127]
    buffer_load_dwordx4 v240, s[16:19], s30 offen offset:0 nt lds
    v_mfma_f32_16x16x32_bf16 v[140:143], a[112:115], a[140:143], v[140:143]
    v_mfma_f32_16x16x32_bf16 v[156:159], a[112:115], a[144:147], v[156:159]
    buffer_load_dwordx4 v241, s[16:19], s30 offen offset:1024 nt lds
    v_mfma_f32_16x16x32_bf16 v[172:175], a[112:115], a[148:151], v[172:175]
    s_waitcnt vmcnt(15) lgkmcnt(0)
    s_barrier
    v_mfma_f32_16x16x32_bf16 v[96:99], a[116:119], a[152:155], v[96:99]
    ds_read_b64_tr_b16 a[100:101], v14 offset:32768
    ds_read_b64_tr_b16 a[102:103], v14 offset:33792
    v_mfma_f32_16x16x32_bf16 v[112:115], a[116:119], a[156:159], v[112:115]
    ds_read_b128 a[132:135], v12 offset:40960
    ds_read_b128 a[136:139], v12 offset:43008
    v_mfma_f32_16x16x32_bf16 v[128:131], a[116:119], a[160:163], v[128:131]
    ds_read_b128 a[140:143], v12 offset:45056
    ds_read_b128 a[144:147], v12 offset:47104
    v_mfma_f32_16x16x32_bf16 v[144:147], a[116:119], a[164:167], v[144:147]
    ds_read_b128 a[148:151], v12 offset:49152
    ds_read_b64_tr_b16 a[104:105], v14 offset:32776
    v_mfma_f32_16x16x32_bf16 v[160:163], a[116:119], a[168:171], v[160:163]
    ds_read_b64_tr_b16 a[106:107], v14 offset:33800
    ds_read_b64_tr_b16 a[108:109], v15 offset:32768
    v_mfma_f32_16x16x32_bf16 v[100:103], a[120:123], a[152:155], v[100:103]
    ds_read_b64_tr_b16 a[110:111], v15 offset:33792
    ds_read_b64_tr_b16 a[112:113], v15 offset:32776
    v_mfma_f32_16x16x32_bf16 v[116:119], a[120:123], a[156:159], v[116:119]
    ds_read_b64_tr_b16 a[114:115], v15 offset:33800
    v_mfma_f32_16x16x32_bf16 v[132:135], a[120:123], a[160:163], v[132:135]
    s_add_u32 s46, s46, 128
    s_add_u32 s47, s47, 0x80000
    s_cmp_eq_u32 s46, s42
    s_cselect_b32 s46, s40, s46
    s_cselect_b32 s47, s41, s47
    s_add_u32 m0, s50, 16384
    v_mfma_f32_16x16x32_bf16 v[148:151], a[120:123], a[164:167], v[148:151]
    buffer_load_dwordx4 v8, s[20:23], s47 offen lds
    v_mfma_f32_16x16x32_bf16 v[164:167], a[120:123], a[168:171], v[164:167]
    s_add_u32 m0, s49, 20480
    v_mfma_f32_16x16x32_bf16 v[104:107], a[124:127], a[152:155], v[104:107]
    buffer_load_dwordx4 v3, s[8:11], s46 offen lds
    v_mfma_f32_16x16x32_bf16 v[120:123], a[124:127], a[156:159], v[120:123]
    s_add_u32 m0, s50, 20480
    v_mfma_f32_16x16x32_bf16 v[136:139], a[124:127], a[160:163], v[136:139]
    buffer_load_dwordx4 v9, s[20:23], s47 offen lds
    v_mfma_f32_16x16x32_bf16 v[152:155], a[124:127], a[164:167], v[152:155]
    s_add_u32 m0, s49, 24576
    v_mfma_f32_16x16x32_bf16 v[168:171], a[124:127], a[168:171], v[168:171]
    buffer_load_dwordx4 v4, s[8:11], s46 offen lds
    v_mfma_f32_16x16x32_bf16 v[108:111], a[128:131], a[152:155], v[108:111]
    s_add_u32 m0, s50, 24576
    v_mfma_f32_16x16x32_bf16 v[124:127], a[128:131], a[156:159], v[124:127]
    buffer_load_dwordx4 v10, s[20:23], s47 offen lds
    v_mfma_f32_16x16x32_bf16 v[140:143], a[128:131], a[160:163], v[140:143]
    s_add_u32 m0, s49, 28672
    v_mfma_f32_16x16x32_bf16 v[156:159], a[128:131], a[164:167], v[156:159]
    buffer_load_dwordx4 v5, s[8:11], s46 offen lds
    v_mfma_f32_16x16x32_bf16 v[172:175], a[128:131], a[168:171], v[172:175]
    s_waitcnt lgkmcnt(0)
    v_mfma_f32_16x16x32_bf16 v[96:99], a[100:103], a[132:135], v[96:99]
    ds_read_b64_tr_b16 a[116:117], v14 offset:40960
    ds_read_b64_tr_b16 a[118:119], v14 offset:41984
    v_mfma_f32_16x16x32_bf16 v[112:115], a[100:103], a[136:139], v[112:115]
    ds_read_b128 a[152:155], v13 offset:40960
    ds_read_b128 a[156:159], v13 offset:43008
    v_mfma_f32_16x16x32_bf16 v[128:131], a[100:103], a[140:143], v[128:131]
    ds_read_b128 a[160:163], v13 offset:45056
    ds_read_b128 a[164:167], v13 offset:47104
    v_mfma_f32_16x16x32_bf16 v[144:147], a[100:103], a[144:147], v[144:147]
    ds_read_b128 a[168:171], v13 offset:49152
    ds_read_b64_tr_b16 a[120:121], v14 offset:40968
    v_mfma_f32_16x16x32_bf16 v[160:163], a[100:103], a[148:151], v[160:163]
    ds_read_b64_tr_b16 a[122:123], v14 offset:41992
    ds_read_b64_tr_b16 a[124:125], v15 offset:40960
    v_mfma_f32_16x16x32_bf16 v[100:103], a[104:107], a[132:135], v[100:103]
    ds_read_b64_tr_b16 a[126:127], v15 offset:41984
    ds_read_b64_tr_b16 a[128:129], v15 offset:40968
    v_mfma_f32_16x16x32_bf16 v[116:119], a[104:107], a[136:139], v[116:119]
    ds_read_b64_tr_b16 a[130:131], v15 offset:41992
    v_mfma_f32_16x16x32_bf16 v[132:135], a[104:107], a[140:143], v[132:135]
    s_add_u32 m0, s50, 28672
    v_mfma_f32_16x16x32_bf16 v[148:151], a[104:107], a[144:147], v[148:151]
    buffer_load_dwordx4 v11, s[20:23], s47 offen lds
    v_mfma_f32_16x16x32_bf16 v[164:167], a[104:107], a[148:151], v[164:167]
    s_add_u32 m0, s49, 32768
    v_mfma_f32_16x16x32_bf16 v[104:107], a[108:111], a[132:135], v[104:107]
    buffer_load_dwordx4 v6, s[8:11], s46 offen lds
    v_mfma_f32_16x16x32_bf16 v[120:123], a[108:111], a[136:139], v[120:123]
    s_add_u32 m0, s49, 36864
    v_mfma_f32_16x16x32_bf16 v[136:139], a[108:111], a[140:143], v[136:139]
    buffer_load_dwordx4 v7, s[8:11], s46 offen lds
    v_mfma_f32_16x16x32_bf16 v[152:155], a[108:111], a[144:147], v[152:155]
    s_add_u32 m0, s31, 8192
    v_mfma_f32_16x16x32_bf16 v[168:171], a[108:111], a[148:151], v[168:171]
    buffer_load_dwordx4 v240, s[16:19], s30 offen offset:2048 nt lds
    v_mfma_f32_16x16x32_bf16 v[108:111], a[112:115], a[132:135], v[108:111]
    v_mfma_f32_16x16x32_bf16 v[124:127], a[112:115], a[136:139], v[124:127]
    buffer_load_dwordx4 v241, s[16:19], s30 offen offset:3072 nt lds
    s_add_u32 s30, s30, 8192
    s_cmp_eq_u32 s30, s101
    s_cselect_b32 s30, s100, s30
    v_mfma_f32_16x16x32_bf16 v[140:143], a[112:115], a[140:143], v[140:143]
    v_mfma_f32_16x16x32_bf16 v[156:159], a[112:115], a[144:147], v[156:159]
    v_mfma_f32_16x16x32_bf16 v[172:175], a[112:115], a[148:151], v[172:175]
    s_waitcnt vmcnt(14) lgkmcnt(0)
    s_barrier
    v_mfma_f32_16x16x32_bf16 v[96:99], a[116:119], a[152:155], v[96:99]
    ds_read_b64_tr_b16 a[100:101], v14 offset:0
    ds_read_b64_tr_b16 a[102:103], v14 offset:1024
    v_mfma_f32_16x16x32_bf16 v[112:115], a[116:119], a[156:159], v[112:115]
    ds_read_b128 a[132:135], v12 offset:0
    ds_read_b128 a[136:139], v12 offset:2048
    v_mfma_f32_16x16x32_bf16 v[128:131], a[116:119], a[160:163], v[128:131]
    ds_read_b128 a[140:143], v12 offset:4096
    ds_read_b128 a[144:147], v12 offset:6144
    v_mfma_f32_16x16x32_bf16 v[144:147], a[116:119], a[164:167], v[144:147]
    ds_read_b128 a[148:151], v12 offset:8192
    ds_read_b64_tr_b16 a[104:105], v14 offset:8
    v_mfma_f32_16x16x32_bf16 v[160:163], a[116:119], a[168:171], v[160:163]
    ds_read_b64_tr_b16 a[106:107], v14 offset:1032
    ds_read_b64_tr_b16 a[108:109], v15 offset:0
    v_mfma_f32_16x16x32_bf16 v[100:103], a[120:123], a[152:155], v[100:103]
    ds_read_b64_tr_b16 a[110:111], v15 offset:1024
    ds_read_b64_tr_b16 a[112:113], v15 offset:8
    v_mfma_f32_16x16x32_bf16 v[116:119], a[120:123], a[156:159], v[116:119]
    ds_read_b64_tr_b16 a[114:115], v15 offset:1032
    v_mfma_f32_16x16x32_bf16 v[132:135], a[120:123], a[160:163], v[132:135]
    s_add_u32 s46, s46, 128
    s_add_u32 s47, s47, 0x80000
    s_cmp_eq_u32 s46, s42
    s_cselect_b32 s46, s40, s46
    s_cselect_b32 s47, s41, s47
    s_add_u32 m0, s50, 32768
    v_mfma_f32_16x16x32_bf16 v[148:151], a[120:123], a[164:167], v[148:151]
    buffer_load_dwordx4 v8, s[20:23], s47 offen lds
    v_mfma_f32_16x16x32_bf16 v[164:167], a[120:123], a[168:171], v[164:167]
    s_add_u32 m0, s49, 40960
    v_mfma_f32_16x16x32_bf16 v[104:107], a[124:127], a[152:155], v[104:107]
    buffer_load_dwordx4 v3, s[8:11], s46 offen lds
    v_mfma_f32_16x16x32_bf16 v[120:123], a[124:127], a[156:159], v[120:123]
    s_add_u32 m0, s50, 36864
    v_mfma_f32_16x16x32_bf16 v[136:139], a[124:127], a[160:163], v[136:139]
    buffer_load_dwordx4 v9, s[20:23], s47 offen lds
    v_mfma_f32_16x16x32_bf16 v[152:155], a[124:127], a[164:167], v[152:155]
    s_add_u32 m0, s49, 45056
    v_mfma_f32_16x16x32_bf16 v[168:171], a[124:127], a[168:171], v[168:171]
    buffer_load_dwordx4 v4, s[8:11], s46 offen lds
    v_mfma_f32_16x16x32_bf16 v[108:111], a[128:131], a[152:155], v[108:111]
    s_add_u32 m0, s50, 40960
    v_mfma_f32_16x16x32_bf16 v[124:127], a[128:131], a[156:159], v[124:127]
    buffer_load_dwordx4 v10, s[20:23], s47 offen lds
    v_mfma_f32_16x16x32_bf16 v[140:143], a[128:131], a[160:163], v[140:143]
    s_add_u32 m0, s49, 49152
    v_mfma_f32_16x16x32_bf16 v[156:159], a[128:131], a[164:167], v[156:159]
    buffer_load_dwordx4 v5, s[8:11], s46 offen lds
    v_mfma_f32_16x16x32_bf16 v[172:175], a[128:131], a[168:171], v[172:175]
    s_waitcnt lgkmcnt(0)
    v_mfma_f32_16x16x32_bf16 v[96:99], a[100:103], a[132:135], v[96:99]
    ds_read_b64_tr_b16 a[116:117], v14 offset:8192
    ds_read_b64_tr_b16 a[118:119], v14 offset:9216
    v_mfma_f32_16x16x32_bf16 v[112:115], a[100:103], a[136:139], v[112:115]
    ds_read_b128 a[152:155], v13 offset:0
    ds_read_b128 a[156:159], v13 offset:2048
    v_mfma_f32_16x16x32_bf16 v[128:131], a[100:103], a[140:143], v[128:131]
    ds_read_b128 a[160:163], v13 offset:4096
    ds_read_b128 a[164:167], v13 offset:6144
    v_mfma_f32_16x16x32_bf16 v[144:147], a[100:103], a[144:147], v[144:147]
    ds_read_b128 a[168:171], v13 offset:8192
    ds_read_b64_tr_b16 a[120:121], v14 offset:8200
    v_mfma_f32_16x16x32_bf16 v[160:163], a[100:103], a[148:151], v[160:163]
    ds_read_b64_tr_b16 a[122:123], v14 offset:9224
    ds_read_b64_tr_b16 a[124:125], v15 offset:8192
    v_mfma_f32_16x16x32_bf16 v[100:103], a[104:107], a[132:135], v[100:103]
    ds_read_b64_tr_b16 a[126:127], v15 offset:9216
    ds_read_b64_tr_b16 a[128:129], v15 offset:8200
    v_mfma_f32_16x16x32_bf16 v[116:119], a[104:107], a[136:139], v[116:119]
    ds_read_b64_tr_b16 a[130:131], v15 offset:9224
    v_mfma_f32_16x16x32_bf16 v[132:135], a[104:107], a[140:143], v[132:135]
    s_add_u32 m0, s50, 45056
    v_mfma_f32_16x16x32_bf16 v[148:151], a[104:107], a[144:147], v[148:151]
    buffer_load_dwordx4 v11, s[20:23], s47 offen lds
    v_mfma_f32_16x16x32_bf16 v[164:167], a[104:107], a[148:151], v[164:167]
    s_add_u32 m0, s49, 53248
    v_mfma_f32_16x16x32_bf16 v[104:107], a[108:111], a[132:135], v[104:107]
    buffer_load_dwordx4 v6, s[8:11], s46 offen lds
    v_mfma_f32_16x16x32_bf16 v[120:123], a[108:111], a[136:139], v[120:123]
    s_add_u32 m0, s49, 57344
    v_mfma_f32_16x16x32_bf16 v[136:139], a[108:111], a[140:143], v[136:139]
    buffer_load_dwordx4 v7, s[8:11], s46 offen lds
    v_mfma_f32_16x16x32_bf16 v[152:155], a[108:111], a[144:147], v[152:155]
    v_mfma_f32_16x16x32_bf16 v[168:171], a[108:111], a[148:151], v[168:171]
    v_mfma_f32_16x16x32_bf16 v[108:111], a[112:115], a[132:135], v[108:111]
    v_mfma_f32_16x16x32_bf16 v[124:127], a[112:115], a[136:139], v[124:127]
    v_mfma_f32_16x16x32_bf16 v[140:143], a[112:115], a[140:143], v[140:143]
    v_mfma_f32_16x16x32_bf16 v[156:159], a[112:115], a[144:147], v[156:159]
    v_mfma_f32_16x16x32_bf16 v[172:175], a[112:115], a[148:151], v[172:175]
    s_waitcnt vmcnt(11) lgkmcnt(0)
    s_barrier
    v_mfma_f32_16x16x32_bf16 v[96:99], a[116:119], a[152:155], v[96:99]
    ds_read_b64_tr_b16 a[100:101], v14 offset:16384
    ds_read_b64_tr_b16 a[102:103], v14 offset:17408
    v_mfma_f32_16x16x32_bf16 v[112:115], a[116:119], a[156:159], v[112:115]
    ds_read_b128 a[132:135], v12 offset:20480
    ds_read_b128 a[136:139], v12 offset:22528
    v_mfma_f32_16x16x32_bf16 v[128:131], a[116:119], a[160:163], v[128:131]
    ds_read_b128 a[140:143], v12 offset:24576
    ds_read_b128 a[144:147], v12 offset:26624
    v_mfma_f32_16x16x32_bf16 v[144:147], a[116:119], a[164:167], v[144:147]
    ds_read_b128 a[148:151], v12 offset:28672
    ds_read_b64_tr_b16 a[104:105], v14 offset:16392
    v_mfma_f32_16x16x32_bf16 v[160:163], a[116:119], a[168:171], v[160:163]
    ds_read_b64_tr_b16 a[106:107], v14 offset:17416
    ds_read_b64_tr_b16 a[108:109], v15 offset:16384
    v_mfma_f32_16x16x32_bf16 v[100:103], a[120:123], a[152:155], v[100:103]
    ds_read_b64_tr_b16 a[110:111], v15 offset:17408
    ds_read_b64_tr_b16 a[112:113], v15 offset:16392
    v_mfma_f32_16x16x32_bf16 v[116:119], a[120:123], a[156:159], v[116:119]
    ds_read_b64_tr_b16 a[114:115], v15 offset:17416
    v_mfma_f32_16x16x32_bf16 v[132:135], a[120:123], a[160:163], v[132:135]
    s_add_u32 m0, s31, 16384
    v_mfma_f32_16x16x32_bf16 v[148:151], a[120:123], a[164:167], v[148:151]
    buffer_load_dwordx4 v236, s[12:15], s30 offen offset:0 nt lds
    v_mfma_f32_16x16x32_bf16 v[164:167], a[120:123], a[168:171], v[164:167]
    v_mfma_f32_16x16x32_bf16 v[104:107], a[124:127], a[152:155], v[104:107]
    buffer_load_dwordx4 v237, s[12:15], s30 offen offset:1024 nt lds
    v_mfma_f32_16x16x32_bf16 v[120:123], a[124:127], a[156:159], v[120:123]
    v_mfma_f32_16x16x32_bf16 v[136:139], a[124:127], a[160:163], v[136:139]
    buffer_load_dwordx4 v238, s[12:15], s30 offen offset:2048 nt lds
    v_mfma_f32_16x16x32_bf16 v[152:155], a[124:127], a[164:167], v[152:155]
    v_mfma_f32_16x16x32_bf16 v[168:171], a[124:127], a[168:171], v[168:171]
    buffer_load_dwordx4 v239, s[12:15], s30 offen offset:3072 nt lds
    v_mfma_f32_16x16x32_bf16 v[108:111], a[128:131], a[152:155], v[108:111]
    s_add_u32 m0, s31, 24576
    v_mfma_f32_16x16x32_bf16 v[124:127], a[128:131], a[156:159], v[124:127]
    buffer_load_dwordx4 v240, s[16:19], s30 offen offset:0 nt lds
    v_mfma_f32_16x16x32_bf16 v[140:143], a[128:131], a[160:163], v[140:143]
    v_mfma_f32_16x16x32_bf16 v[156:159], a[128:131], a[164:167], v[156:159]
    buffer_load_dwordx4 v241, s[16:19], s30 offen offset:1024 nt lds
    v_mfma_f32_16x16x32_bf16 v[172:175], a[128:131], a[168:171], v[172:175]
    s_waitcnt lgkmcnt(0)
    v_mfma_f32_16x16x32_bf16 v[96:99], a[100:103], a[132:135], v[96:99]
    ds_read_b64_tr_b16 a[116:117], v14 offset:24576
    ds_read_b64_tr_b16 a[118:119], v14 offset:25600
    v_mfma_f32_16x16x32_bf16 v[112:115], a[100:103], a[136:139], v[112:115]
    ds_read_b128 a[152:155], v13 offset:20480
    ds_read_b128 a[156:159], v13 offset:22528
    v_mfma_f32_16x16x32_bf16 v[128:131], a[100:103], a[140:143], v[128:131]
    ds_read_b128 a[160:163], v13 offset:24576
    ds_read_b128 a[164:167], v13 offset:26624
    v_mfma_f32_16x16x32_bf16 v[144:147], a[100:103], a[144:147], v[144:147]
    ds_read_b128 a[168:171], v13 offset:28672
    ds_read_b64_tr_b16 a[120:121], v14 offset:24584
    v_mfma_f32_16x16x32_bf16 v[160:163], a[100:103], a[148:151], v[160:163]
    ds_read_b64_tr_b16 a[122:123], v14 offset:25608
    ds_read_b64_tr_b16 a[124:125], v15 offset:24576
    v_mfma_f32_16x16x32_bf16 v[100:103], a[104:107], a[132:135], v[100:103]
    ds_read_b64_tr_b16 a[126:127], v15 offset:25600
    ds_read_b64_tr_b16 a[128:129], v15 offset:24584
    v_mfma_f32_16x16x32_bf16 v[116:119], a[104:107], a[136:139], v[116:119]
    ds_read_b64_tr_b16 a[130:131], v15 offset:25608
    v_mfma_f32_16x16x32_bf16 v[132:135], a[104:107], a[140:143], v[132:135]
    v_mfma_f32_16x16x32_bf16 v[148:151], a[104:107], a[144:147], v[148:151]
    buffer_load_dwordx4 v240, s[16:19], s30 offen offset:2048 nt lds
    v_mfma_f32_16x16x32_bf16 v[164:167], a[104:107], a[148:151], v[164:167]
    v_mfma_f32_16x16x32_bf16 v[104:107], a[108:111], a[132:135], v[104:107]
    buffer_load_dwordx4 v241, s[16:19], s30 offen offset:3072 nt lds
    v_mfma_f32_16x16x32_bf16 v[120:123], a[108:111], a[136:139], v[120:123]
    s_add_u32 s30, s30, 8192
    s_cmp_eq_u32 s30, s101
    s_cselect_b32 s30, s100, s30
    v_mfma_f32_16x16x32_bf16 v[136:139], a[108:111], a[140:143], v[136:139]
    v_mfma_f32_16x16x32_bf16 v[152:155], a[108:111], a[144:147], v[152:155]
    v_mfma_f32_16x16x32_bf16 v[168:171], a[108:111], a[148:151], v[168:171]
    v_mfma_f32_16x16x32_bf16 v[108:111], a[112:115], a[132:135], v[108:111]
    v_mfma_f32_16x16x32_bf16 v[124:127], a[112:115], a[136:139], v[124:127]
    v_mfma_f32_16x16x32_bf16 v[140:143], a[112:115], a[140:143], v[140:143]
    v_mfma_f32_16x16x32_bf16 v[156:159], a[112:115], a[144:147], v[156:159]
    v_mfma_f32_16x16x32_bf16 v[172:175], a[112:115], a[148:151], v[172:175]
    s_waitcnt vmcnt(8) lgkmcnt(0)
    s_barrier
    v_mfma_f32_16x16x32_bf16 v[96:99], a[116:119], a[152:155], v[96:99]
    ds_read_b64_tr_b16 a[100:101], v14 offset:32768
    ds_read_b64_tr_b16 a[102:103], v14 offset:33792
    v_mfma_f32_16x16x32_bf16 v[112:115], a[116:119], a[156:159], v[112:115]
    ds_read_b128 a[132:135], v12 offset:40960
    ds_read_b128 a[136:139], v12 offset:43008
    v_mfma_f32_16x16x32_bf16 v[128:131], a[116:119], a[160:163], v[128:131]
    ds_read_b128 a[140:143], v12 offset:45056
    ds_read_b128 a[144:147], v12 offset:47104
    v_mfma_f32_16x16x32_bf16 v[144:147], a[116:119], a[164:167], v[144:147]
    ds_read_b128 a[148:151], v12 offset:49152
    ds_read_b64_tr_b16 a[104:105], v14 offset:32776
    v_mfma_f32_16x16x32_bf16 v[160:163], a[116:119], a[168:171], v[160:163]
    ds_read_b64_tr_b16 a[106:107], v14 offset:33800
    ds_read_b64_tr_b16 a[108:109], v15 offset:32768
    v_mfma_f32_16x16x32_bf16 v[100:103], a[120:123], a[152:155], v[100:103]
    ds_read_b64_tr_b16 a[110:111], v15 offset:33792
    ds_read_b64_tr_b16 a[112:113], v15 offset:32776
    v_mfma_f32_16x16x32_bf16 v[116:119], a[120:123], a[156:159], v[116:119]
    ds_read_b64_tr_b16 a[114:115], v15 offset:33800
    v_mfma_f32_16x16x32_bf16 v[132:135], a[120:123], a[160:163], v[132:135]
    s_add_u32 m0, s31, 32768
    v_mfma_f32_16x16x32_bf16 v[148:151], a[120:123], a[164:167], v[148:151]
    buffer_load_dwordx4 v236, s[12:15], s30 offen offset:0 nt lds
    v_mfma_f32_16x16x32_bf16 v[164:167], a[120:123], a[168:171], v[164:167]
    v_mfma_f32_16x16x32_bf16 v[104:107], a[124:127], a[152:155], v[104:107]
    buffer_load_dwordx4 v237, s[12:15], s30 offen offset:1024 nt lds
    v_mfma_f32_16x16x32_bf16 v[120:123], a[124:127], a[156:159], v[120:123]
    v_mfma_f32_16x16x32_bf16 v[136:139], a[124:127], a[160:163], v[136:139]
    buffer_load_dwordx4 v238, s[12:15], s30 offen offset:2048 nt lds
    v_mfma_f32_16x16x32_bf16 v[152:155], a[124:127], a[164:167], v[152:155]
    v_mfma_f32_16x16x32_bf16 v[168:171], a[124:127], a[168:171], v[168:171]
    buffer_load_dwordx4 v239, s[12:15], s30 offen offset:3072 nt lds
    v_mfma_f32_16x16x32_bf16 v[108:111], a[128:131], a[152:155], v[108:111]
    s_add_u32 m0, s31, 40960
    v_mfma_f32_16x16x32_bf16 v[124:127], a[128:131], a[156:159], v[124:127]
    buffer_load_dwordx4 v240, s[16:19], s30 offen offset:0 nt lds
    v_mfma_f32_16x16x32_bf16 v[140:143], a[128:131], a[160:163], v[140:143]
    v_mfma_f32_16x16x32_bf16 v[156:159], a[128:131], a[164:167], v[156:159]
    buffer_load_dwordx4 v241, s[16:19], s30 offen offset:1024 nt lds
    v_mfma_f32_16x16x32_bf16 v[172:175], a[128:131], a[168:171], v[172:175]
    s_waitcnt lgkmcnt(0)
    v_mfma_f32_16x16x32_bf16 v[96:99], a[100:103], a[132:135], v[96:99]
    ds_read_b64_tr_b16 a[116:117], v14 offset:40960
    ds_read_b64_tr_b16 a[118:119], v14 offset:41984
    v_mfma_f32_16x16x32_bf16 v[112:115], a[100:103], a[136:139], v[112:115]
    ds_read_b128 a[152:155], v13 offset:40960
    ds_read_b128 a[156:159], v13 offset:43008
    v_mfma_f32_16x16x32_bf16 v[128:131], a[100:103], a[140:143], v[128:131]
    ds_read_b128 a[160:163], v13 offset:45056
    ds_read_b128 a[164:167], v13 offset:47104
    v_mfma_f32_16x16x32_bf16 v[144:147], a[100:103], a[144:147], v[144:147]
    ds_read_b128 a[168:171], v13 offset:49152
    ds_read_b64_tr_b16 a[120:121], v14 offset:40968
    v_mfma_f32_16x16x32_bf16 v[160:163], a[100:103], a[148:151], v[160:163]
    ds_read_b64_tr_b16 a[122:123], v14 offset:41992
    ds_read_b64_tr_b16 a[124:125], v15 offset:40960
    v_mfma_f32_16x16x32_bf16 v[100:103], a[104:107], a[132:135], v[100:103]
    ds_read_b64_tr_b16 a[126:127], v15 offset:41984
    ds_read_b64_tr_b16 a[128:129], v15 offset:40968
    v_mfma_f32_16x16x32_bf16 v[116:119], a[104:107], a[136:139], v[116:119]
    ds_read_b64_tr_b16 a[130:131], v15 offset:41992
    v_mfma_f32_16x16x32_bf16 v[132:135], a[104:107], a[140:143], v[132:135]
    v_mfma_f32_16x16x32_bf16 v[148:151], a[104:107], a[144:147], v[148:151]
    buffer_load_dwordx4 v240, s[16:19], s30 offen offset:2048 nt lds
    v_mfma_f32_16x16x32_bf16 v[164:167], a[104:107], a[148:151], v[164:167]
    v_mfma_f32_16x16x32_bf16 v[104:107], a[108:111], a[132:135], v[104:107]
    buffer_load_dwordx4 v241, s[16:19], s30 offen offset:3072 nt lds
    v_mfma_f32_16x16x32_bf16 v[120:123], a[108:111], a[136:139], v[120:123]
    s_add_u32 s30, s30, 8192
    s_cmp_eq_u32 s30, s101
    s_cselect_b32 s30, s100, s30
    v_mfma_f32_16x16x32_bf16 v[136:139], a[108:111], a[140:143], v[136:139]
    v_mfma_f32_16x16x32_bf16 v[152:155], a[108:111], a[144:147], v[152:155]
    v_mfma_f32_16x16x32_bf16 v[168:171], a[108:111], a[148:151], v[168:171]
    v_mfma_f32_16x16x32_bf16 v[108:111], a[112:115], a[132:135], v[108:111]
    v_mfma_f32_16x16x32_bf16 v[124:127], a[112:115], a[136:139], v[124:127]
    v_mfma_f32_16x16x32_bf16 v[140:143], a[112:115], a[140:143], v[140:143]
    v_mfma_f32_16x16x32_bf16 v[156:159], a[112:115], a[144:147], v[156:159]
    v_mfma_f32_16x16x32_bf16 v[172:175], a[112:115], a[148:151], v[172:175]
    s_waitcnt lgkmcnt(0)
    s_barrier
    v_mfma_f32_16x16x32_bf16 v[96:99], a[116:119], a[152:155], v[96:99]
    v_mfma_f32_16x16x32_bf16 v[112:115], a[116:119], a[156:159], v[112:115]
    v_mfma_f32_16x16x32_bf16 v[128:131], a[116:119], a[160:163], v[128:131]
    v_mfma_f32_16x16x32_bf16 v[144:147], a[116:119], a[164:167], v[144:147]
    v_mfma_f32_16x16x32_bf16 v[160:163], a[116:119], a[168:171], v[160:163]
    v_mfma_f32_16x16x32_bf16 v[100:103], a[120:123], a[152:155], v[100:103]
    v_mfma_f32_16x16x32_bf16 v[116:119], a[120:123], a[156:159], v[116:119]
    v_mfma_f32_16x16x32_bf16 v[132:135], a[120:123], a[160:163], v[132:135]
    v_mfma_f32_16x16x32_bf16 v[148:151], a[120:123], a[164:167], v[148:151]
    v_mfma_f32_16x16x32_bf16 v[164:167], a[120:123], a[168:171], v[164:167]
    v_mfma_f32_16x16x32_bf16 v[104:107], a[124:127], a[152:155], v[104:107]
    v_mfma_f32_16x16x32_bf16 v[120:123], a[124:127], a[156:159], v[120:123]
    v_mfma_f32_16x16x32_bf16 v[136:139], a[124:127], a[160:163], v[136:139]
    v_mfma_f32_16x16x32_bf16 v[152:155], a[124:127], a[164:167], v[152:155]
    v_mfma_f32_16x16x32_bf16 v[168:171], a[124:127], a[168:171], v[168:171]
    v_mfma_f32_16x16x32_bf16 v[108:111], a[128:131], a[152:155], v[108:111]
    v_mfma_f32_16x16x32_bf16 v[124:127], a[128:131], a[156:159], v[124:127]
    v_mfma_f32_16x16x32_bf16 v[140:143], a[128:131], a[160:163], v[140:143]
    v_mfma_f32_16x16x32_bf16 v[156:159], a[128:131], a[164:167], v[156:159]
    v_mfma_f32_16x16x32_bf16 v[172:175], a[128:131], a[168:171], v[172:175]
    s_mov_b32 s34, 0x3e0293ee
    s_mov_b32 s35, 0x3e0293ee
    ds_read_b128 a[100:103], v224 offset:0
    ds_read_b128 a[104:107], v225 offset:0
    ds_read_b128 a[108:111], v226 offset:0
    ds_read_b128 a[112:115], v227 offset:0
    ds_read_b128 a[116:119], v224 offset:4096
    ds_read_b128 a[120:123], v225 offset:4096
    ds_read_b128 a[124:127], v226 offset:4096
    ds_read_b128 a[128:131], v227 offset:4096
    ds_read_b64_tr_b16 a[164:165], v228 offset:0
    ds_read_b64_tr_b16 a[166:167], v228 offset:4096
    ds_read_b64_tr_b16 a[168:169], v229 offset:0
    ds_read_b64_tr_b16 a[170:171], v229 offset:4096
    ds_read_b64_tr_b16 a[172:173], v230 offset:0
    ds_read_b64_tr_b16 a[174:175], v230 offset:4096
    ds_read_b64_tr_b16 a[176:177], v231 offset:0
    ds_read_b64_tr_b16 a[178:179], v231 offset:4096
    ds_read_b64_tr_b16 a[180:181], v232 offset:0
    ds_read_b64_tr_b16 a[182:183], v232 offset:4096
    ds_read_b64_tr_b16 a[184:185], v233 offset:0
    ds_read_b64_tr_b16 a[186:187], v233 offset:4096
    ds_read_b64_tr_b16 a[188:189], v234 offset:0
    ds_read_b64_tr_b16 a[190:191], v234 offset:4096
    ds_read_b64_tr_b16 a[192:193], v235 offset:0
    ds_read_b64_tr_b16 a[194:195], v235 offset:4096
    v_pk_mul_f32 v[96:97], v[96:97], s[34:35]
    v_pk_mul_f32 v[98:99], v[98:99], s[34:35]
    v_pk_mul_f32 v[100:101], v[100:101], s[34:35]
    v_pk_mul_f32 v[102:103], v[102:103], s[34:35]
    v_pk_mul_f32 v[104:105], v[104:105], s[34:35]
    v_pk_mul_f32 v[106:107], v[106:107], s[34:35]
    v_pk_mul_f32 v[108:109], v[108:109], s[34:35]
    v_pk_mul_f32 v[110:111], v[110:111], s[34:35]
    v_cvt_pk_bf16_f32 v16, v96, v97
    v_cvt_pk_bf16_f32 v17, v98, v99
    v_cvt_pk_bf16_f32 v18, v100, v101
    v_cvt_pk_bf16_f32 v19, v102, v103
    v_cvt_pk_bf16_f32 v20, v104, v105
    v_cvt_pk_bf16_f32 v21, v106, v107
    v_cvt_pk_bf16_f32 v22, v108, v109
    v_cvt_pk_bf16_f32 v23, v110, v111
    ds_write_b128 v242, v[16:19] offset:0
    ds_write_b128 v242, v[20:23] offset:1024
    v_pk_mul_f32 v[112:113], v[112:113], s[34:35]
    v_pk_mul_f32 v[114:115], v[114:115], s[34:35]
    v_pk_mul_f32 v[116:117], v[116:117], s[34:35]
    v_pk_mul_f32 v[118:119], v[118:119], s[34:35]
    v_pk_mul_f32 v[120:121], v[120:121], s[34:35]
    v_pk_mul_f32 v[122:123], v[122:123], s[34:35]
    v_pk_mul_f32 v[124:125], v[124:125], s[34:35]
    v_pk_mul_f32 v[126:127], v[126:127], s[34:35]
    v_cvt_pk_bf16_f32 v32, v112, v113
    v_cvt_pk_bf16_f32 v33, v114, v115
    v_cvt_pk_bf16_f32 v34, v116, v117
    v_cvt_pk_bf16_f32 v35, v118, v119
    v_cvt_pk_bf16_f32 v36, v120, v121
    v_cvt_pk_bf16_f32 v37, v122, v123
    v_cvt_pk_bf16_f32 v38, v124, v125
    v_cvt_pk_bf16_f32 v39, v126, v127
    ds_write_b128 v242, v[32:35] offset:2048
    ds_write_b128 v242, v[36:39] offset:3072
    v_pk_mul_f32 v[128:129], v[128:129], s[34:35]
    v_pk_mul_f32 v[130:131], v[130:131], s[34:35]
    v_pk_mul_f32 v[132:133], v[132:133], s[34:35]
    v_pk_mul_f32 v[134:135], v[134:135], s[34:35]
    v_pk_mul_f32 v[136:137], v[136:137], s[34:35]
    v_pk_mul_f32 v[138:139], v[138:139], s[34:35]
    v_pk_mul_f32 v[140:141], v[140:141], s[34:35]
    v_pk_mul_f32 v[142:143], v[142:143], s[34:35]
    v_cvt_pk_bf16_f32 v48, v128, v129
    v_cvt_pk_bf16_f32 v49, v130, v131
    v_cvt_pk_bf16_f32 v50, v132, v133
    v_cvt_pk_bf16_f32 v51, v134, v135
    v_cvt_pk_bf16_f32 v52, v136, v137
    v_cvt_pk_bf16_f32 v53, v138, v139
    v_cvt_pk_bf16_f32 v54, v140, v141
    v_cvt_pk_bf16_f32 v55, v142, v143
    ds_write_b128 v242, v[48:51] offset:4096
    ds_write_b128 v242, v[52:55] offset:5120
    v_pk_mul_f32 v[144:145], v[144:145], s[34:35]
    v_pk_mul_f32 v[146:147], v[146:147], s[34:35]
    v_pk_mul_f32 v[148:149], v[148:149], s[34:35]
    v_pk_mul_f32 v[150:151], v[150:151], s[34:35]
    v_pk_mul_f32 v[152:153], v[152:153], s[34:35]
    v_pk_mul_f32 v[154:155], v[154:155], s[34:35]
    v_pk_mul_f32 v[156:157], v[156:157], s[34:35]
    v_pk_mul_f32 v[158:159], v[158:159], s[34:35]
    v_cvt_pk_bf16_f32 v64, v144, v145
    v_cvt_pk_bf16_f32 v65, v146, v147
    v_cvt_pk_bf16_f32 v66, v148, v149
    v_cvt_pk_bf16_f32 v67, v150, v151
    v_cvt_pk_bf16_f32 v68, v152, v153
    v_cvt_pk_bf16_f32 v69, v154, v155
    v_cvt_pk_bf16_f32 v70, v156, v157
    v_cvt_pk_bf16_f32 v71, v158, v159
    ds_write_b128 v242, v[64:67] offset:6144
    ds_write_b128 v242, v[68:71] offset:7168
    v_pk_mul_f32 v[160:161], v[160:161], s[34:35]
    v_pk_mul_f32 v[162:163], v[162:163], s[34:35]
    v_pk_mul_f32 v[164:165], v[164:165], s[34:35]
    v_pk_mul_f32 v[166:167], v[166:167], s[34:35]
    v_pk_mul_f32 v[168:169], v[168:169], s[34:35]
    v_pk_mul_f32 v[170:171], v[170:171], s[34:35]
    v_pk_mul_f32 v[172:173], v[172:173], s[34:35]
    v_pk_mul_f32 v[174:175], v[174:175], s[34:35]
    v_cvt_pk_bf16_f32 v80, v160, v161
    v_cvt_pk_bf16_f32 v81, v162, v163
    v_cvt_pk_bf16_f32 v82, v164, v165
    v_cvt_pk_bf16_f32 v83, v166, v167
    v_cvt_pk_bf16_f32 v84, v168, v169
    v_cvt_pk_bf16_f32 v85, v170, v171
    v_cvt_pk_bf16_f32 v86, v172, v173
    v_cvt_pk_bf16_f32 v87, v174, v175
    ds_write_b128 v242, v[80:83] offset:8192
    ds_write_b128 v242, v[84:87] offset:9216
    v_pk_mov_b32 v[96:97], 0, 0
    v_pk_mov_b32 v[98:99], 0, 0
    v_pk_mov_b32 v[100:101], 0, 0
    v_pk_mov_b32 v[102:103], 0, 0
    v_pk_mov_b32 v[104:105], 0, 0
    v_pk_mov_b32 v[106:107], 0, 0
    v_pk_mov_b32 v[108:109], 0, 0
    v_pk_mov_b32 v[110:111], 0, 0
    v_pk_mov_b32 v[112:113], 0, 0
    v_pk_mov_b32 v[114:115], 0, 0
    v_pk_mov_b32 v[116:117], 0, 0
    v_pk_mov_b32 v[118:119], 0, 0
    v_pk_mov_b32 v[120:121], 0, 0
    v_pk_mov_b32 v[122:123], 0, 0
    v_pk_mov_b32 v[124:125], 0, 0
    v_pk_mov_b32 v[126:127], 0, 0
    v_pk_mov_b32 v[128:129], 0, 0
    v_pk_mov_b32 v[130:131], 0, 0
    v_pk_mov_b32 v[132:133], 0, 0
    v_pk_mov_b32 v[134:135], 0, 0
    v_pk_mov_b32 v[136:137], 0, 0
    v_pk_mov_b32 v[138:139], 0, 0
    v_pk_mov_b32 v[140:141], 0, 0
    v_pk_mov_b32 v[142:143], 0, 0
    s_waitcnt vmcnt(8) lgkmcnt(0)
    s_barrier
    ds_read_b128 v[24:27], v243 offset:0
    ds_read_b128 v[28:31], v243 offset:1024
    ds_read_b128 v[40:43], v243 offset:2048
    ds_read_b128 v[44:47], v243 offset:3072
    ds_read_b128 v[56:59], v243 offset:4096
    ds_read_b128 v[60:63], v243 offset:5120
    ds_read_b128 v[72:75], v243 offset:6144
    ds_read_b128 v[76:79], v243 offset:7168
    ds_read_b128 v[88:91], v243 offset:8192
    ds_read_b128 v[92:95], v243 offset:9216
    v_pk_mov_b32 v[144:145], 0, 0
    v_pk_mov_b32 v[146:147], 0, 0
    v_pk_mov_b32 v[148:149], 0, 0
    v_pk_mov_b32 v[150:151], 0, 0
    v_pk_mov_b32 v[152:153], 0, 0
    v_pk_mov_b32 v[154:155], 0, 0
    v_pk_mov_b32 v[156:157], 0, 0
    v_pk_mov_b32 v[158:159], 0, 0
    v_pk_mov_b32 v[160:161], 0, 0
    v_pk_mov_b32 v[162:163], 0, 0
    v_pk_mov_b32 v[164:165], 0, 0
    v_pk_mov_b32 v[166:167], 0, 0
    v_pk_mov_b32 v[168:169], 0, 0
    v_pk_mov_b32 v[170:171], 0, 0
    v_pk_mov_b32 v[172:173], 0, 0
    v_pk_mov_b32 v[174:175], 0, 0
    s_and_b32 s34, s2, 7
    s_lshr_b32 s35, s2, 3
    s_mul_i32 s36, s34, 30
    s_min_u32 s37, s34, 3
    s_add_u32 s36, s36, s37
    s_add_u32 s36, s36, s35
    s_lshr_b32 s40, s36, 2
    s_and_b32 s41, s36, 3
    s_sub_u32 s37, s36, 108
    s_mul_i32 s38, s37, 13108
    s_lshr_b32 s38, s38, 16
    s_mul_i32 s39, s38, 5
    s_sub_u32 s39, s37, s39
    s_add_u32 s39, s39, 4
    s_cmp_ge_u32 s36, 108
    s_cselect_b32 s40, s38, s40
    s_cselect_b32 s41, s39, s41
    s_mul_i32 s43, s3, 1179648
    s_lshl_b32 s44, s3, 12
    s_lshl_b32 s34, s41, 7
    v_lshrrev_b32 v244, 3, v2
    v_mul_u32_u24 v244, 1152, v244
    v_add_u32 v244, s34, v244
    v_lshrrev_b32 v245, 4, v2
    v_lshlrev_b32 v245, 1, v245
    v_and_b32 v246, 7, v2
    v_xor_b32 v245, v245, v246
    v_lshl_add_u32 v3, v245, 4, v244
    v_add_u32 v4, 8192, v3
    v_add_u32 v5, 16384, v3
    v_add_u32 v6, 24576, v3
    v_lshlrev_b32 v9, 4, v2
    s_mov_b32 s45, 49152
    s_cmp_eq_u32 s3, 1
    s_cselect_b32 s45, 114688, s45
    s_cmp_eq_u32 s3, 2
    s_cselect_b32 s45, 131072, s45
    s_cmp_eq_u32 s3, 3
    s_cselect_b32 s45, 143360, s45
    s_mov_b32 s46, 32768
    s_cmp_eq_u32 s3, 1
    s_cselect_b32 s46, 40960, s46
    s_cmp_eq_u32 s3, 2
    s_cselect_b32 s46, 98304, s46
    s_cmp_eq_u32 s3, 3
    s_cselect_b32 s46, 106496, s46
    v_add_u32 v7, s45, v9
    v_add_u32 v8, s46, v9
    v_lshrrev_b32 v249, 4, v2
    v_lshrrev_b32 v250, 2, v2
    v_and_b32 v250, 3, v250
    v_lshl_add_u32 v249, v249, 2, v250
    v_lshrrev_b32 v250, 1, v249
    v_and_b32 v250, 3, v250
    v_lshlrev_b32 v249, 7, v249
    v_add_u32 v249, s44, v249
    v_and_b32 v251, 1, v2
    v_lshl_add_u32 v249, v251, 3, v249
    v_lshrrev_b32 v251, 1, v2
    v_and_b32 v251, 1, v251
    v_lshl_add_u32 v249, v251, 4, v249
    v_xor_b32 v251, 0, v250
    v_lshl_add_u32 v10, v251, 5, v249
    v_add_u32 v14, 65536, v10
    v_xor_b32 v251, 1, v250
    v_lshl_add_u32 v11, v251, 5, v249
    v_add_u32 v15, 65536, v11
    v_xor_b32 v251, 2, v250
    v_lshl_add_u32 v12, v251, 5, v249
    v_add_u32 v242, 65536, v12
    v_xor_b32 v251, 3, v250
    v_lshl_add_u32 v13, v251, 5, v249
    v_add_u32 v243, 65536, v13
    s_waitcnt lgkmcnt(8)
L_attn0:
    v_mfma_f32_16x16x32_bf16 v[176:179], a[100:103], v[16:19], v[200:203]
    ds_read_b128 a[132:135], v224 offset:16384
    v_mfma_f32_16x16x32_bf16 v[176:179], a[104:107], v[20:23], v[176:179]
    ds_read_b128 a[136:139], v225 offset:16384
    v_mfma_f32_16x16x32_bf16 v[176:179], a[108:111], v[24:27], v[176:179]
    ds_read_b128 a[140:143], v226 offset:16384
    v_mfma_f32_16x16x32_bf16 v[176:179], a[112:115], v[28:31], v[176:179]
    ds_read_b128 a[144:147], v227 offset:16384
    v_mfma_f32_16x16x32_bf16 v[180:183], a[116:119], v[16:19], v[200:203]
    ds_read_b128 a[148:151], v224 offset:20480
    v_mfma_f32_16x16x32_bf16 v[180:183], a[120:123], v[20:23], v[180:183]
    ds_read_b128 a[152:155], v225 offset:20480
    v_mfma_f32_16x16x32_bf16 v[180:183], a[124:127], v[24:27], v[180:183]
    ds_read_b128 a[156:159], v226 offset:20480
    v_mfma_f32_16x16x32_bf16 v[180:183], a[128:131], v[28:31], v[180:183]
    ds_read_b128 a[160:163], v227 offset:20480
    s_waitcnt lgkmcnt(8)
    s_barrier
    s_add_u32 m0, s31, 49152
    s_nop 0
    buffer_load_dwordx4 v236, s[12:15], s30 offen offset:0 nt lds
    buffer_load_dwordx4 v237, s[12:15], s30 offen offset:1024 nt lds
    buffer_load_dwordx4 v238, s[12:15], s30 offen offset:2048 nt lds
    buffer_load_dwordx4 v239, s[12:15], s30 offen offset:3072 nt lds
    s_add_u32 m0, s31, 57344
    s_nop 0
    buffer_load_dwordx4 v240, s[16:19], s30 offen offset:0 nt lds
    buffer_load_dwordx4 v241, s[16:19], s30 offen offset:1024 nt lds
    buffer_load_dwordx4 v240, s[16:19], s30 offen offset:2048 nt lds
    buffer_load_dwordx4 v241, s[16:19], s30 offen offset:3072 nt lds
    s_add_u32 s30, s30, 8192
    s_cmp_eq_u32 s30, s101
    s_cselect_b32 s30, s100, s30
    s_mov_b32 s32, 0
L_loop:
    v_mfma_f32_16x16x32_bf16 v[184:187], a[100:103], v[32:35], v[204:207]
    v_exp_f32 v176, v176
    v_mfma_f32_16x16x32_bf16 v[184:187], a[104:107], v[36:39], v[184:187]
    v_mfma_f32_16x16x32_bf16 v[184:187], a[108:111], v[40:43], v[184:187]
    v_exp_f32 v177, v177
    v_mfma_f32_16x16x32_bf16 v[184:187], a[112:115], v[44:47], v[184:187]
    v_cvt_pk_bf16_f32 v192, v176, v177
    v_mfma_f32_16x16x32_bf16 v[188:191], a[116:119], v[32:35], v[204:207]
    v_exp_f32 v178, v178
    v_mfma_f32_16x16x32_bf16 v[188:191], a[120:123], v[36:39], v[188:191]
    v_mfma_f32_16x16x32_bf16 v[188:191], a[124:127], v[40:43], v[188:191]
    v_exp_f32 v179, v179
    v_mfma_f32_16x16x32_bf16 v[188:191], a[128:131], v[44:47], v[188:191]
    v_cvt_pk_bf16_f32 v193, v178, v179
    v_mfma_f32_16x16x32_bf16 a[96:99], v[220:223], v[196:199], a[96:99]
    v_exp_f32 v180, v180
    v_mfma_f32_16x16x32_bf16 v[160:163], a[196:199], v[196:199], v[160:163]
    v_mfma_f32_16x16x32_bf16 v[164:167], a[200:203], v[196:199], v[164:167]
    v_exp_f32 v181, v181
    v_mfma_f32_16x16x32_bf16 v[168:171], a[204:207], v[196:199], v[168:171]
    v_cvt_pk_bf16_f32 v194, v180, v181
    s_add_u32 m0, s31, 0
    v_mfma_f32_16x16x32_bf16 v[172:175], a[208:211], v[196:199], v[172:175]
    v_exp_f32 v182, v182
    v_mfma_f32_16x16x32_bf16 a[64:67], a[212:215], v[196:199], a[64:67]
    buffer_load_dwordx4 v236, s[12:15], s30 offen offset:0 nt lds
    v_mfma_f32_16x16x32_bf16 a[68:71], a[216:219], v[196:199], a[68:71]
    v_exp_f32 v183, v183
    v_mfma_f32_16x16x32_bf16 a[72:75], a[220:223], v[196:199], a[72:75]
    v_cvt_pk_bf16_f32 v195, v182, v183
    v_mfma_f32_16x16x32_bf16 a[76:79], a[224:227], v[196:199], a[76:79]
    buffer_load_dwordx4 v237, s[12:15], s30 offen offset:1024 nt lds
    v_mfma_f32_16x16x32_bf16 v[176:179], a[100:103], v[48:51], v[208:211]
    v_exp_f32 v184, v184
    v_mfma_f32_16x16x32_bf16 v[176:179], a[104:107], v[52:55], v[176:179]
    ds_read_b64_tr_b16 a[196:197], v228 offset:16384
    ds_read_b64_tr_b16 a[198:199], v228 offset:20480
    v_mfma_f32_16x16x32_bf16 v[176:179], a[108:111], v[56:59], v[176:179]
    v_exp_f32 v185, v185
    v_mfma_f32_16x16x32_bf16 v[176:179], a[112:115], v[60:63], v[176:179]
    ds_read_b64_tr_b16 a[200:201], v229 offset:16384
    v_cvt_pk_bf16_f32 v196, v184, v185
    v_mfma_f32_16x16x32_bf16 v[180:183], a[116:119], v[48:51], v[208:211]
    v_exp_f32 v186, v186
    v_mfma_f32_16x16x32_bf16 v[180:183], a[120:123], v[52:55], v[180:183]
    ds_read_b64_tr_b16 a[202:203], v229 offset:20480
    ds_read_b64_tr_b16 a[204:205], v230 offset:16384
    v_mfma_f32_16x16x32_bf16 v[180:183], a[124:127], v[56:59], v[180:183]
    v_exp_f32 v187, v187
    v_mfma_f32_16x16x32_bf16 v[180:183], a[128:131], v[60:63], v[180:183]
    ds_read_b64_tr_b16 a[206:207], v230 offset:20480
    v_cvt_pk_bf16_f32 v197, v186, v187
    v_mfma_f32_16x16x32_bf16 a[80:83], v[220:223], v[192:195], a[80:83]
    v_exp_f32 v188, v188
    v_mfma_f32_16x16x32_bf16 v[96:99], a[164:167], v[192:195], v[96:99]
    v_mfma_f32_16x16x32_bf16 v[100:103], a[168:171], v[192:195], v[100:103]
    v_exp_f32 v189, v189
    v_mfma_f32_16x16x32_bf16 v[104:107], a[172:175], v[192:195], v[104:107]
    v_cvt_pk_bf16_f32 v198, v188, v189
    v_mfma_f32_16x16x32_bf16 v[108:111], a[176:179], v[192:195], v[108:111]
    v_exp_f32 v190, v190
    v_mfma_f32_16x16x32_bf16 a[0:3], a[180:183], v[192:195], a[0:3]
    buffer_load_dwordx4 v238, s[12:15], s30 offen offset:2048 nt lds
    v_mfma_f32_16x16x32_bf16 a[4:7], a[184:187], v[192:195], a[4:7]
    v_exp_f32 v191, v191
    v_mfma_f32_16x16x32_bf16 a[8:11], a[188:191], v[192:195], a[8:11]
    v_cvt_pk_bf16_f32 v199, v190, v191
    v_mfma_f32_16x16x32_bf16 a[12:15], a[192:195], v[192:195], a[12:15]
    buffer_load_dwordx4 v239, s[12:15], s30 offen offset:3072 nt lds
    v_mfma_f32_16x16x32_bf16 v[184:187], a[100:103], v[64:67], v[212:215]
    v_exp_f32 v176, v176
    v_mfma_f32_16x16x32_bf16 v[184:187], a[104:107], v[68:71], v[184:187]
    ds_read_b64_tr_b16 a[208:209], v231 offset:16384
    ds_read_b64_tr_b16 a[210:211], v231 offset:20480
    v_mfma_f32_16x16x32_bf16 v[184:187], a[108:111], v[72:75], v[184:187]
    v_exp_f32 v177, v177
    v_mfma_f32_16x16x32_bf16 v[184:187], a[112:115], v[76:79], v[184:187]
    ds_read_b64_tr_b16 a[212:213], v232 offset:16384
    v_cvt_pk_bf16_f32 v192, v176, v177
    v_mfma_f32_16x16x32_bf16 v[188:191], a[116:119], v[64:67], v[212:215]
    v_exp_f32 v178, v178
    v_mfma_f32_16x16x32_bf16 v[188:191], a[120:123], v[68:71], v[188:191]
    ds_read_b64_tr_b16 a[214:215], v232 offset:20480
    ds_read_b64_tr_b16 a[216:217], v233 offset:16384
    v_mfma_f32_16x16x32_bf16 v[188:191], a[124:127], v[72:75], v[188:191]
    v_exp_f32 v179, v179
    v_mfma_f32_16x16x32_bf16 v[188:191], a[128:131], v[76:79], v[188:191]
    ds_read_b64_tr_b16 a[218:219], v233 offset:20480
    v_cvt_pk_bf16_f32 v193, v178, v179
    v_mfma_f32_16x16x32_bf16 a[84:87], v[220:223], v[196:199], a[84:87]
    v_exp_f32 v180, v180
    v_mfma_f32_16x16x32_bf16 v[112:115], a[164:167], v[196:199], v[112:115]
    v_mfma_f32_16x16x32_bf16 v[116:119], a[168:171], v[196:199], v[116:119]
    v_exp_f32 v181, v181
    v_mfma_f32_16x16x32_bf16 v[120:123], a[172:175], v[196:199], v[120:123]
    v_cvt_pk_bf16_f32 v194, v180, v181
    s_add_u32 m0, s31, 8192
    v_mfma_f32_16x16x32_bf16 v[124:127], a[176:179], v[196:199], v[124:127]
    v_exp_f32 v182, v182
    v_mfma_f32_16x16x32_bf16 a[16:19], a[180:183], v[196:199], a[16:19]
    buffer_load_dwordx4 v240, s[16:19], s30 offen offset:0 nt lds
    v_mfma_f32_16x16x32_bf16 a[20:23], a[184:187], v[196:199], a[20:23]
    v_exp_f32 v183, v183
    v_mfma_f32_16x16x32_bf16 a[24:27], a[188:191], v[196:199], a[24:27]
    v_cvt_pk_bf16_f32 v195, v182, v183
    v_mfma_f32_16x16x32_bf16 a[28:31], a[192:195], v[196:199], a[28:31]
    buffer_load_dwordx4 v241, s[16:19], s30 offen offset:1024 nt lds
    v_mfma_f32_16x16x32_bf16 v[176:179], a[100:103], v[80:83], v[216:219]
    v_exp_f32 v184, v184
    v_mfma_f32_16x16x32_bf16 v[176:179], a[104:107], v[84:87], v[176:179]
    ds_read_b64_tr_b16 a[220:221], v234 offset:16384
    ds_read_b64_tr_b16 a[222:223], v234 offset:20480
    v_mfma_f32_16x16x32_bf16 v[176:179], a[108:111], v[88:91], v[176:179]
    v_exp_f32 v185, v185
    v_mfma_f32_16x16x32_bf16 v[176:179], a[112:115], v[92:95], v[176:179]
    ds_read_b64_tr_b16 a[224:225], v235 offset:16384
    v_cvt_pk_bf16_f32 v196, v184, v185
    v_mfma_f32_16x16x32_bf16 v[180:183], a[116:119], v[80:83], v[216:219]
    v_exp_f32 v186, v186
    v_mfma_f32_16x16x32_bf16 v[180:183], a[120:123], v[84:87], v[180:183]
    ds_read_b64_tr_b16 a[226:227], v235 offset:20480
    v_mfma_f32_16x16x32_bf16 v[180:183], a[124:127], v[88:91], v[180:183]
    v_exp_f32 v187, v187
    v_mfma_f32_16x16x32_bf16 v[180:183], a[128:131], v[92:95], v[180:183]
    v_cvt_pk_bf16_f32 v197, v186, v187
    v_mfma_f32_16x16x32_bf16 a[88:91], v[220:223], v[192:195], a[88:91]
    v_exp_f32 v188, v188
    v_mfma_f32_16x16x32_bf16 v[128:131], a[164:167], v[192:195], v[128:131]
    buffer_load_dwordx4 v240, s[16:19], s30 offen offset:2048 nt lds
    v_mfma_f32_16x16x32_bf16 v[132:135], a[168:171], v[192:195], v[132:135]
    v_exp_f32 v189, v189
    v_mfma_f32_16x16x32_bf16 v[136:139], a[172:175], v[192:195], v[136:139]
    v_cvt_pk_bf16_f32 v198, v188, v189
    v_mfma_f32_16x16x32_bf16 v[140:143], a[176:179], v[192:195], v[140:143]
    v_exp_f32 v190, v190
    v_mfma_f32_16x16x32_bf16 a[32:35], a[180:183], v[192:195], a[32:35]
    buffer_load_dwordx4 v241, s[16:19], s30 offen offset:3072 nt lds
    v_mfma_f32_16x16x32_bf16 a[36:39], a[184:187], v[192:195], a[36:39]
    v_exp_f32 v191, v191
    v_mfma_f32_16x16x32_bf16 a[40:43], a[188:191], v[192:195], a[40:43]
    v_cvt_pk_bf16_f32 v199, v190, v191
    v_mfma_f32_16x16x32_bf16 a[44:47], a[192:195], v[192:195], a[44:47]
    s_waitcnt vmcnt(16) lgkmcnt(0)
    s_barrier
    v_mfma_f32_16x16x32_bf16 v[184:187], a[132:135], v[16:19], v[200:203]
    v_exp_f32 v176, v176
    v_mfma_f32_16x16x32_bf16 v[184:187], a[136:139], v[20:23], v[184:187]
    ds_read_b128 a[100:103], v224 offset:32768
    ds_read_b128 a[104:107], v225 offset:32768
    v_mfma_f32_16x16x32_bf16 v[184:187], a[140:143], v[24:27], v[184:187]
    v_exp_f32 v177, v177
    v_mfma_f32_16x16x32_bf16 v[184:187], a[144:147], v[28:31], v[184:187]
    ds_read_b128 a[108:111], v226 offset:32768
    v_cvt_pk_bf16_f32 v192, v176, v177
    v_mfma_f32_16x16x32_bf16 v[188:191], a[148:151], v[16:19], v[200:203]
    v_exp_f32 v178, v178
    v_mfma_f32_16x16x32_bf16 v[188:191], a[152:155], v[20:23], v[188:191]
    ds_read_b128 a[112:115], v227 offset:32768
    ds_read_b128 a[116:119], v224 offset:36864
    v_mfma_f32_16x16x32_bf16 v[188:191], a[156:159], v[24:27], v[188:191]
    v_exp_f32 v179, v179
    v_mfma_f32_16x16x32_bf16 v[188:191], a[160:163], v[28:31], v[188:191]
    ds_read_b128 a[120:123], v225 offset:36864
    v_cvt_pk_bf16_f32 v193, v178, v179
    v_mfma_f32_16x16x32_bf16 a[92:95], v[220:223], v[196:199], a[92:95]
    v_exp_f32 v180, v180
    v_mfma_f32_16x16x32_bf16 v[144:147], a[164:167], v[196:199], v[144:147]
    ds_read_b128 a[124:127], v226 offset:36864
    ds_read_b128 a[128:131], v227 offset:36864
    v_mfma_f32_16x16x32_bf16 v[148:151], a[168:171], v[196:199], v[148:151]
    v_exp_f32 v181, v181
    v_mfma_f32_16x16x32_bf16 v[152:155], a[172:175], v[196:199], v[152:155]
    v_cvt_pk_bf16_f32 v194, v180, v181
    s_add_u32 s30, s30, 8192
    v_mfma_f32_16x16x32_bf16 v[156:159], a[176:179], v[196:199], v[156:159]
    v_exp_f32 v182, v182
    v_mfma_f32_16x16x32_bf16 a[48:51], a[180:183], v[196:199], a[48:51]
    s_cmp_eq_u32 s30, s101
    s_cselect_b32 s30, s100, s30
    v_mfma_f32_16x16x32_bf16 a[52:55], a[184:187], v[196:199], a[52:55]
    v_exp_f32 v183, v183
    v_mfma_f32_16x16x32_bf16 a[56:59], a[188:191], v[196:199], a[56:59]
    v_cvt_pk_bf16_f32 v195, v182, v183
    v_mfma_f32_16x16x32_bf16 a[60:63], a[192:195], v[196:199], a[60:63]
    v_mfma_f32_16x16x32_bf16 v[176:179], a[132:135], v[32:35], v[204:207]
    v_exp_f32 v184, v184
    v_mfma_f32_16x16x32_bf16 v[176:179], a[136:139], v[36:39], v[176:179]
    v_mfma_f32_16x16x32_bf16 v[176:179], a[140:143], v[40:43], v[176:179]
    v_exp_f32 v185, v185
    v_mfma_f32_16x16x32_bf16 v[176:179], a[144:147], v[44:47], v[176:179]
    v_cvt_pk_bf16_f32 v196, v184, v185
    v_mfma_f32_16x16x32_bf16 v[180:183], a[148:151], v[32:35], v[204:207]
    v_exp_f32 v186, v186
    v_mfma_f32_16x16x32_bf16 v[180:183], a[152:155], v[36:39], v[180:183]
    v_mfma_f32_16x16x32_bf16 v[180:183], a[156:159], v[40:43], v[180:183]
    v_exp_f32 v187, v187
    v_mfma_f32_16x16x32_bf16 v[180:183], a[160:163], v[44:47], v[180:183]
    v_cvt_pk_bf16_f32 v197, v186, v187
    v_mfma_f32_16x16x32_bf16 a[96:99], v[220:223], v[192:195], a[96:99]
    v_exp_f32 v188, v188
    v_mfma_f32_16x16x32_bf16 v[160:163], a[164:167], v[192:195], v[160:163]
    v_mfma_f32_16x16x32_bf16 v[164:167], a[168:171], v[192:195], v[164:167]
    v_exp_f32 v189, v189
    v_mfma_f32_16x16x32_bf16 v[168:171], a[172:175], v[192:195], v[168:171]
    v_cvt_pk_bf16_f32 v198, v188, v189
    s_add_u32 m0, s31, 16384
    v_mfma_f32_16x16x32_bf16 v[172:175], a[176:179], v[192:195], v[172:175]
    v_exp_f32 v190, v190
    v_mfma_f32_16x16x32_bf16 a[64:67], a[180:183], v[192:195], a[64:67]
    buffer_load_dwordx4 v236, s[12:15], s30 offen offset:0 nt lds
    v_mfma_f32_16x16x32_bf16 a[68:71], a[184:187], v[192:195], a[68:71]
    v_exp_f32 v191, v191
    v_mfma_f32_16x16x32_bf16 a[72:75], a[188:191], v[192:195], a[72:75]
    v_cvt_pk_bf16_f32 v199, v190, v191
    v_mfma_f32_16x16x32_bf16 a[76:79], a[192:195], v[192:195], a[76:79]
    buffer_load_dwordx4 v237, s[12:15], s30 offen offset:1024 nt lds
    v_mfma_f32_16x16x32_bf16 v[184:187], a[132:135], v[48:51], v[208:211]
    v_exp_f32 v176, v176
    v_mfma_f32_16x16x32_bf16 v[184:187], a[136:139], v[52:55], v[184:187]
    ds_read_b64_tr_b16 a[164:165], v228 offset:32768
    ds_read_b64_tr_b16 a[166:167], v228 offset:36864
    v_mfma_f32_16x16x32_bf16 v[184:187], a[140:143], v[56:59], v[184:187]
    v_exp_f32 v177, v177
    v_mfma_f32_16x16x32_bf16 v[184:187], a[144:147], v[60:63], v[184:187]
    ds_read_b64_tr_b16 a[168:169], v229 offset:32768
    v_cvt_pk_bf16_f32 v192, v176, v177
    v_mfma_f32_16x16x32_bf16 v[188:191], a[148:151], v[48:51], v[208:211]
    v_exp_f32 v178, v178
    v_mfma_f32_16x16x32_bf16 v[188:191], a[152:155], v[52:55], v[188:191]
    ds_read_b64_tr_b16 a[170:171], v229 offset:36864
    ds_read_b64_tr_b16 a[172:173], v230 offset:32768
    v_mfma_f32_16x16x32_bf16 v[188:191], a[156:159], v[56:59], v[188:191]
    v_exp_f32 v179, v179
    v_mfma_f32_16x16x32_bf16 v[188:191], a[160:163], v[60:63], v[188:191]
    ds_read_b64_tr_b16 a[174:175], v230 offset:36864
    v_cvt_pk_bf16_f32 v193, v178, v179
    v_mfma_f32_16x16x32_bf16 a[80:83], v[220:223], v[196:199], a[80:83]
    v_exp_f32 v180, v180
    v_mfma_f32_16x16x32_bf16 v[96:99], a[196:199], v[196:199], v[96:99]
    v_mfma_f32_16x16x32_bf16 v[100:103], a[200:203], v[196:199], v[100:103]
    v_exp_f32 v181, v181
    v_mfma_f32_16x16x32_bf16 v[104:107], a[204:207], v[196:199], v[104:107]
    v_cvt_pk_bf16_f32 v194, v180, v181
    v_mfma_f32_16x16x32_bf16 v[108:111], a[208:211], v[196:199], v[108:111]
    v_exp_f32 v182, v182
    v_mfma_f32_16x16x32_bf16 a[0:3], a[212:215], v[196:199], a[0:3]
    buffer_load_dwordx4 v238, s[12:15], s30 offen offset:2048 nt lds
    v_mfma_f32_16x16x32_bf16 a[4:7], a[216:219], v[196:199], a[4:7]
    v_exp_f32 v183, v183
    v_mfma_f32_16x16x32_bf16 a[8:11], a[220:223], v[196:199], a[8:11]
    v_cvt_pk_bf16_f32 v195, v182, v183
    v_mfma_f32_16x16x32_bf16 a[12:15], a[224:227], v[196:199], a[12:15]
    buffer_load_dwordx4 v239, s[12:15], s30 offen offset:3072 nt lds
    v_mfma_f32_16x16x32_bf16 v[176:179], a[132:135], v[64:67], v[212:215]
    v_exp_f32 v184, v184
    v_mfma_f32_16x16x32_bf16 v[176:179], a[136:139], v[68:71], v[176:179]
    ds_read_b64_tr_b16 a[176:177], v231 offset:32768
    ds_read_b64_tr_b16 a[178:179], v231 offset:36864
    v_mfma_f32_16x16x32_bf16 v[176:179], a[140:143], v[72:75], v[176:179]
    v_exp_f32 v185, v185
    v_mfma_f32_16x16x32_bf16 v[176:179], a[144:147], v[76:79], v[176:179]
    ds_read_b64_tr_b16 a[180:181], v232 offset:32768
    v_cvt_pk_bf16_f32 v196, v184, v185
    v_mfma_f32_16x16x32_bf16 v[180:183], a[148:151], v[64:67], v[212:215]
    v_exp_f32 v186, v186
    v_mfma_f32_16x16x32_bf16 v[180:183], a[152:155], v[68:71], v[180:183]
    ds_read_b64_tr_b16 a[182:183], v232 offset:36864
    ds_read_b64_tr_b16 a[184:185], v233 offset:32768
    v_mfma_f32_16x16x32_bf16 v[180:183], a[156:159], v[72:75], v[180:183]
    v_exp_f32 v187, v187
    v_mfma_f32_16x16x32_bf16 v[180:183], a[160:163], v[76:79], v[180:183]
    ds_read_b64_tr_b16 a[186:187], v233 offset:36864
    v_cvt_pk_bf16_f32 v197, v186, v187
    v_mfma_f32_16x16x32_bf16 a[84:87], v[220:223], v[192:195], a[84:87]
    v_exp_f32 v188, v188
    v_mfma_f32_16x16x32_bf16 v[112:115], a[196:199], v[192:195], v[112:115]
    v_mfma_f32_16x16x32_bf16 v[116:119], a[200:203], v[192:195], v[116:119]
    v_exp_f32 v189, v189
    v_mfma_f32_16x16x32_bf16 v[120:123], a[204:207], v[192:195], v[120:123]
    v_cvt_pk_bf16_f32 v198, v188, v189
    s_add_u32 m0, s31, 24576
    v_mfma_f32_16x16x32_bf16 v[124:127], a[208:211], v[192:195], v[124:127]
    v_exp_f32 v190, v190
    v_mfma_f32_16x16x32_bf16 a[16:19], a[212:215], v[192:195], a[16:19]
    buffer_load_dwordx4 v240, s[16:19], s30 offen offset:0 nt lds
    v_mfma_f32_16x16x32_bf16 a[20:23], a[216:219], v[192:195], a[20:23]
    v_exp_f32 v191, v191
    v_mfma_f32_16x16x32_bf16 a[24:27], a[220:223], v[192:195], a[24:27]
    v_cvt_pk_bf16_f32 v199, v190, v191
    v_mfma_f32_16x16x32_bf16 a[28:31], a[224:227], v[192:195], a[28:31]
    buffer_load_dwordx4 v241, s[16:19], s30 offen offset:1024 nt lds
    v_mfma_f32_16x16x32_bf16 v[184:187], a[132:135], v[80:83], v[216:219]
    v_exp_f32 v176, v176
    v_mfma_f32_16x16x32_bf16 v[184:187], a[136:139], v[84:87], v[184:187]
    ds_read_b64_tr_b16 a[188:189], v234 offset:32768
    ds_read_b64_tr_b16 a[190:191], v234 offset:36864
    v_mfma_f32_16x16x32_bf16 v[184:187], a[140:143], v[88:91], v[184:187]
    v_exp_f32 v177, v177
    v_mfma_f32_16x16x32_bf16 v[184:187], a[144:147], v[92:95], v[184:187]
    ds_read_b64_tr_b16 a[192:193], v235 offset:32768
    v_cvt_pk_bf16_f32 v192, v176, v177
    v_mfma_f32_16x16x32_bf16 v[188:191], a[148:151], v[80:83], v[216:219]
    v_exp_f32 v178, v178
    v_mfma_f32_16x16x32_bf16 v[188:191], a[152:155], v[84:87], v[188:191]
    ds_read_b64_tr_b16 a[194:195], v235 offset:36864
    v_mfma_f32_16x16x32_bf16 v[188:191], a[156:159], v[88:91], v[188:191]
    v_exp_f32 v179, v179
    v_mfma_f32_16x16x32_bf16 v[188:191], a[160:163], v[92:95], v[188:191]
    v_cvt_pk_bf16_f32 v193, v178, v179
    v_mfma_f32_16x16x32_bf16 a[88:91], v[220:223], v[196:199], a[88:91]
    v_exp_f32 v180, v180
    v_mfma_f32_16x16x32_bf16 v[128:131], a[196:199], v[196:199], v[128:131]
    buffer_load_dwordx4 v240, s[16:19], s30 offen offset:2048 nt lds
    v_mfma_f32_16x16x32_bf16 v[132:135], a[200:203], v[196:199], v[132:135]
    v_exp_f32 v181, v181
    v_mfma_f32_16x16x32_bf16 v[136:139], a[204:207], v[196:199], v[136:139]
    v_cvt_pk_bf16_f32 v194, v180, v181
    v_mfma_f32_16x16x32_bf16 v[140:143], a[208:211], v[196:199], v[140:143]
    v_exp_f32 v182, v182
    v_mfma_f32_16x16x32_bf16 a[32:35], a[212:215], v[196:199], a[32:35]
    buffer_load_dwordx4 v241, s[16:19], s30 offen offset:3072 nt lds
    v_mfma_f32_16x16x32_bf16 a[36:39], a[216:219], v[196:199], a[36:39]
    v_exp_f32 v183, v183
    v_mfma_f32_16x16x32_bf16 a[40:43], a[220:223], v[196:199], a[40:43]
    v_cvt_pk_bf16_f32 v195, v182, v183
    v_mfma_f32_16x16x32_bf16 a[44:47], a[224:227], v[196:199], a[44:47]
    s_waitcnt vmcnt(16) lgkmcnt(0)
    s_barrier
    v_mfma_f32_16x16x32_bf16 v[176:179], a[100:103], v[16:19], v[200:203]
    v_exp_f32 v184, v184
    v_mfma_f32_16x16x32_bf16 v[176:179], a[104:107], v[20:23], v[176:179]
    ds_read_b128 a[132:135], v224 offset:49152
    ds_read_b128 a[136:139], v225 offset:49152
    v_mfma_f32_16x16x32_bf16 v[176:179], a[108:111], v[24:27], v[176:179]
    v_exp_f32 v185, v185
    v_mfma_f32_16x16x32_bf16 v[176:179], a[112:115], v[28:31], v[176:179]
    ds_read_b128 a[140:143], v226 offset:49152
    v_cvt_pk_bf16_f32 v196, v184, v185
    v_mfma_f32_16x16x32_bf16 v[180:183], a[116:119], v[16:19], v[200:203]
    v_exp_f32 v186, v186
    v_mfma_f32_16x16x32_bf16 v[180:183], a[120:123], v[20:23], v[180:183]
    ds_read_b128 a[144:147], v227 offset:49152
    ds_read_b128 a[148:151], v224 offset:53248
    v_mfma_f32_16x16x32_bf16 v[180:183], a[124:127], v[24:27], v[180:183]
    v_exp_f32 v187, v187
    v_mfma_f32_16x16x32_bf16 v[180:183], a[128:131], v[28:31], v[180:183]
    ds_read_b128 a[152:155], v225 offset:53248
    v_cvt_pk_bf16_f32 v197, v186, v187
    v_mfma_f32_16x16x32_bf16 a[92:95], v[220:223], v[192:195], a[92:95]
    v_exp_f32 v188, v188
    v_mfma_f32_16x16x32_bf16 v[144:147], a[196:199], v[192:195], v[144:147]
    ds_read_b128 a[156:159], v226 offset:53248
    ds_read_b128 a[160:163], v227 offset:53248
    v_mfma_f32_16x16x32_bf16 v[148:151], a[200:203], v[192:195], v[148:151]
    v_exp_f32 v189, v189
    v_mfma_f32_16x16x32_bf16 v[152:155], a[204:207], v[192:195], v[152:155]
    v_cvt_pk_bf16_f32 v198, v188, v189
    s_add_u32 s30, s30, 8192
    v_mfma_f32_16x16x32_bf16 v[156:159], a[208:211], v[192:195], v[156:159]
    v_exp_f32 v190, v190
    v_mfma_f32_16x16x32_bf16 a[48:51], a[212:215], v[192:195], a[48:51]
    s_cmp_eq_u32 s30, s101
    s_cselect_b32 s30, s100, s30
    v_mfma_f32_16x16x32_bf16 a[52:55], a[216:219], v[192:195], a[52:55]
    v_exp_f32 v191, v191
    v_mfma_f32_16x16x32_bf16 a[56:59], a[220:223], v[192:195], a[56:59]
    v_cvt_pk_bf16_f32 v199, v190, v191
    v_mfma_f32_16x16x32_bf16 a[60:63], a[224:227], v[192:195], a[60:63]
    v_mfma_f32_16x16x32_bf16 v[184:187], a[100:103], v[32:35], v[204:207]
    v_exp_f32 v176, v176
    v_mfma_f32_16x16x32_bf16 v[184:187], a[104:107], v[36:39], v[184:187]
    v_mfma_f32_16x16x32_bf16 v[184:187], a[108:111], v[40:43], v[184:187]
    v_exp_f32 v177, v177
    v_mfma_f32_16x16x32_bf16 v[184:187], a[112:115], v[44:47], v[184:187]
    v_cvt_pk_bf16_f32 v192, v176, v177
    v_mfma_f32_16x16x32_bf16 v[188:191], a[116:119], v[32:35], v[204:207]
    v_exp_f32 v178, v178
    v_mfma_f32_16x16x32_bf16 v[188:191], a[120:123], v[36:39], v[188:191]
    v_mfma_f32_16x16x32_bf16 v[188:191], a[124:127], v[40:43], v[188:191]
    v_exp_f32 v179, v179
    v_mfma_f32_16x16x32_bf16 v[188:191], a[128:131], v[44:47], v[188:191]
    v_cvt_pk_bf16_f32 v193, v178, v179
    v_mfma_f32_16x16x32_bf16 a[96:99], v[220:223], v[196:199], a[96:99]
    v_exp_f32 v180, v180
    v_mfma_f32_16x16x32_bf16 v[160:163], a[196:199], v[196:199], v[160:163]
    v_mfma_f32_16x16x32_bf16 v[164:167], a[200:203], v[196:199], v[164:167]
    v_exp_f32 v181, v181
    v_mfma_f32_16x16x32_bf16 v[168:171], a[204:207], v[196:199], v[168:171]
    v_cvt_pk_bf16_f32 v194, v180, v181
    s_add_u32 m0, s31, 32768
    v_mfma_f32_16x16x32_bf16 v[172:175], a[208:211], v[196:199], v[172:175]
    v_exp_f32 v182, v182
    v_mfma_f32_16x16x32_bf16 a[64:67], a[212:215], v[196:199], a[64:67]
    buffer_load_dwordx4 v236, s[12:15], s30 offen offset:0 nt lds
    v_mfma_f32_16x16x32_bf16 a[68:71], a[216:219], v[196:199], a[68:71]
    v_exp_f32 v183, v183
    v_mfma_f32_16x16x32_bf16 a[72:75], a[220:223], v[196:199], a[72:75]
    v_cvt_pk_bf16_f32 v195, v182, v183
    v_mfma_f32_16x16x32_bf16 a[76:79], a[224:227], v[196:199], a[76:79]
    buffer_load_dwordx4 v237, s[12:15], s30 offen offset:1024 nt lds
    v_mfma_f32_16x16x32_bf16 v[176:179], a[100:103], v[48:51], v[208:211]
    v_exp_f32 v184, v184
    v_mfma_f32_16x16x32_bf16 v[176:179], a[104:107], v[52:55], v[176:179]
    ds_read_b64_tr_b16 a[196:197], v228 offset:49152
    ds_read_b64_tr_b16 a[198:199], v228 offset:53248
    v_mfma_f32_16x16x32_bf16 v[176:179], a[108:111], v[56:59], v[176:179]
    v_exp_f32 v185, v185
    v_mfma_f32_16x16x32_bf16 v[176:179], a[112:115], v[60:63], v[176:179]
    ds_read_b64_tr_b16 a[200:201], v229 offset:49152
    v_cvt_pk_bf16_f32 v196, v184, v185
    v_mfma_f32_16x16x32_bf16 v[180:183], a[116:119], v[48:51], v[208:211]
    v_exp_f32 v186, v186
    v_mfma_f32_16x16x32_bf16 v[180:183], a[120:123], v[52:55], v[180:183]
    ds_read_b64_tr_b16 a[202:203], v229 offset:53248
    ds_read_b64_tr_b16 a[204:205], v230 offset:49152
    v_mfma_f32_16x16x32_bf16 v[180:183], a[124:127], v[56:59], v[180:183]
    v_exp_f32 v187, v187
    v_mfma_f32_16x16x32_bf16 v[180:183], a[128:131], v[60:63], v[180:183]
    ds_read_b64_tr_b16 a[206:207], v230 offset:53248
    v_cvt_pk_bf16_f32 v197, v186, v187
    v_mfma_f32_16x16x32_bf16 a[80:83], v[220:223], v[192:195], a[80:83]
    v_exp_f32 v188, v188
    v_mfma_f32_16x16x32_bf16 v[96:99], a[164:167], v[192:195], v[96:99]
    v_mfma_f32_16x16x32_bf16 v[100:103], a[168:171], v[192:195], v[100:103]
    v_exp_f32 v189, v189
    v_mfma_f32_16x16x32_bf16 v[104:107], a[172:175], v[192:195], v[104:107]
    v_cvt_pk_bf16_f32 v198, v188, v189
    v_mfma_f32_16x16x32_bf16 v[108:111], a[176:179], v[192:195], v[108:111]
    v_exp_f32 v190, v190
    v_mfma_f32_16x16x32_bf16 a[0:3], a[180:183], v[192:195], a[0:3]
    buffer_load_dwordx4 v238, s[12:15], s30 offen offset:2048 nt lds
    v_mfma_f32_16x16x32_bf16 a[4:7], a[184:187], v[192:195], a[4:7]
    v_exp_f32 v191, v191
    v_mfma_f32_16x16x32_bf16 a[8:11], a[188:191], v[192:195], a[8:11]
    v_cvt_pk_bf16_f32 v199, v190, v191
    v_mfma_f32_16x16x32_bf16 a[12:15], a[192:195], v[192:195], a[12:15]
    buffer_load_dwordx4 v239, s[12:15], s30 offen offset:3072 nt lds
    v_mfma_f32_16x16x32_bf16 v[184:187], a[100:103], v[64:67], v[212:215]
    v_exp_f32 v176, v176
    v_mfma_f32_16x16x32_bf16 v[184:187], a[104:107], v[68:71], v[184:187]
    ds_read_b64_tr_b16 a[208:209], v231 offset:49152
    ds_read_b64_tr_b16 a[210:211], v231 offset:53248
    v_mfma_f32_16x16x32_bf16 v[184:187], a[108:111], v[72:75], v[184:187]
    v_exp_f32 v177, v177
    v_mfma_f32_16x16x32_bf16 v[184:187], a[112:115], v[76:79], v[184:187]
    ds_read_b64_tr_b16 a[212:213], v232 offset:49152
    v_cvt_pk_bf16_f32 v192, v176, v177
    v_mfma_f32_16x16x32_bf16 v[188:191], a[116:119], v[64:67], v[212:215]
    v_exp_f32 v178, v178
    v_mfma_f32_16x16x32_bf16 v[188:191], a[120:123], v[68:71], v[188:191]
    ds_read_b64_tr_b16 a[214:215], v232 offset:53248
    ds_read_b64_tr_b16 a[216:217], v233 offset:49152
    v_mfma_f32_16x16x32_bf16 v[188:191], a[124:127], v[72:75], v[188:191]
    v_exp_f32 v179, v179
    v_mfma_f32_16x16x32_bf16 v[188:191], a[128:131], v[76:79], v[188:191]
    ds_read_b64_tr_b16 a[218:219], v233 offset:53248
    v_cvt_pk_bf16_f32 v193, v178, v179
    v_mfma_f32_16x16x32_bf16 a[84:87], v[220:223], v[196:199], a[84:87]
    v_exp_f32 v180, v180
    v_mfma_f32_16x16x32_bf16 v[112:115], a[164:167], v[196:199], v[112:115]
    v_mfma_f32_16x16x32_bf16 v[116:119], a[168:171], v[196:199], v[116:119]
    v_exp_f32 v181, v181
    v_mfma_f32_16x16x32_bf16 v[120:123], a[172:175], v[196:199], v[120:123]
    v_cvt_pk_bf16_f32 v194, v180, v181
    s_add_u32 m0, s31, 40960
    v_mfma_f32_16x16x32_bf16 v[124:127], a[176:179], v[196:199], v[124:127]
    v_exp_f32 v182, v182
    v_mfma_f32_16x16x32_bf16 a[16:19], a[180:183], v[196:199], a[16:19]
    buffer_load_dwordx4 v240, s[16:19], s30 offen offset:0 nt lds
    v_mfma_f32_16x16x32_bf16 a[20:23], a[184:187], v[196:199], a[20:23]
    v_exp_f32 v183, v183
    v_mfma_f32_16x16x32_bf16 a[24:27], a[188:191], v[196:199], a[24:27]
    v_cvt_pk_bf16_f32 v195, v182, v183
    v_mfma_f32_16x16x32_bf16 a[28:31], a[192:195], v[196:199], a[28:31]
    buffer_load_dwordx4 v241, s[16:19], s30 offen offset:1024 nt lds
    v_mfma_f32_16x16x32_bf16 v[176:179], a[100:103], v[80:83], v[216:219]
    v_exp_f32 v184, v184
    v_mfma_f32_16x16x32_bf16 v[176:179], a[104:107], v[84:87], v[176:179]
    ds_read_b64_tr_b16 a[220:221], v234 offset:49152
    ds_read_b64_tr_b16 a[222:223], v234 offset:53248
    v_mfma_f32_16x16x32_bf16 v[176:179], a[108:111], v[88:91], v[176:179]
    v_exp_f32 v185, v185
    v_mfma_f32_16x16x32_bf16 v[176:179], a[112:115], v[92:95], v[176:179]
    ds_read_b64_tr_b16 a[224:225], v235 offset:49152
    v_cvt_pk_bf16_f32 v196, v184, v185
    v_mfma_f32_16x16x32_bf16 v[180:183], a[116:119], v[80:83], v[216:219]
    v_exp_f32 v186, v186
    v_mfma_f32_16x16x32_bf16 v[180:183], a[120:123], v[84:87], v[180:183]
    ds_read_b64_tr_b16 a[226:227], v235 offset:53248
    v_mfma_f32_16x16x32_bf16 v[180:183], a[124:127], v[88:91], v[180:183]
    v_exp_f32 v187, v187
    v_mfma_f32_16x16x32_bf16 v[180:183], a[128:131], v[92:95], v[180:183]
    v_cvt_pk_bf16_f32 v197, v186, v187
    v_mfma_f32_16x16x32_bf16 a[88:91], v[220:223], v[192:195], a[88:91]
    v_exp_f32 v188, v188
    v_mfma_f32_16x16x32_bf16 v[128:131], a[164:167], v[192:195], v[128:131]
    buffer_load_dwordx4 v240, s[16:19], s30 offen offset:2048 nt lds
    v_mfma_f32_16x16x32_bf16 v[132:135], a[168:171], v[192:195], v[132:135]
    v_exp_f32 v189, v189
    v_mfma_f32_16x16x32_bf16 v[136:139], a[172:175], v[192:195], v[136:139]
    v_cvt_pk_bf16_f32 v198, v188, v189
    v_mfma_f32_16x16x32_bf16 v[140:143], a[176:179], v[192:195], v[140:143]
    v_exp_f32 v190, v190
    v_mfma_f32_16x16x32_bf16 a[32:35], a[180:183], v[192:195], a[32:35]
    buffer_load_dwordx4 v241, s[16:19], s30 offen offset:3072 nt lds
    v_mfma_f32_16x16x32_bf16 a[36:39], a[184:187], v[192:195], a[36:39]
    v_exp_f32 v191, v191
    v_mfma_f32_16x16x32_bf16 a[40:43], a[188:191], v[192:195], a[40:43]
    v_cvt_pk_bf16_f32 v199, v190, v191
    v_mfma_f32_16x16x32_bf16 a[44:47], a[192:195], v[192:195], a[44:47]
    s_waitcnt vmcnt(16) lgkmcnt(0)
    s_barrier
    v_mfma_f32_16x16x32_bf16 v[184:187], a[132:135], v[16:19], v[200:203]
    v_exp_f32 v176, v176
    v_mfma_f32_16x16x32_bf16 v[184:187], a[136:139], v[20:23], v[184:187]
    ds_read_b128 a[100:103], v224 offset:0
    ds_read_b128 a[104:107], v225 offset:0
    v_mfma_f32_16x16x32_bf16 v[184:187], a[140:143], v[24:27], v[184:187]
    v_exp_f32 v177, v177
    v_mfma_f32_16x16x32_bf16 v[184:187], a[144:147], v[28:31], v[184:187]
    ds_read_b128 a[108:111], v226 offset:0
    v_cvt_pk_bf16_f32 v192, v176, v177
    v_mfma_f32_16x16x32_bf16 v[188:191], a[148:151], v[16:19], v[200:203]
    v_exp_f32 v178, v178
    v_mfma_f32_16x16x32_bf16 v[188:191], a[152:155], v[20:23], v[188:191]
    ds_read_b128 a[112:115], v227 offset:0
    ds_read_b128 a[116:119], v224 offset:4096
    v_mfma_f32_16x16x32_bf16 v[188:191], a[156:159], v[24:27], v[188:191]
    v_exp_f32 v179, v179
    v_mfma_f32_16x16x32_bf16 v[188:191], a[160:163], v[28:31], v[188:191]
    ds_read_b128 a[120:123], v225 offset:4096
    v_cvt_pk_bf16_f32 v193, v178, v179
    v_mfma_f32_16x16x32_bf16 a[92:95], v[220:223], v[196:199], a[92:95]
    v_exp_f32 v180, v180
    v_mfma_f32_16x16x32_bf16 v[144:147], a[164:167], v[196:199], v[144:147]
    ds_read_b128 a[124:127], v226 offset:4096
    ds_read_b128 a[128:131], v227 offset:4096
    v_mfma_f32_16x16x32_bf16 v[148:151], a[168:171], v[196:199], v[148:151]
    v_exp_f32 v181, v181
    v_mfma_f32_16x16x32_bf16 v[152:155], a[172:175], v[196:199], v[152:155]
    v_cvt_pk_bf16_f32 v194, v180, v181
    s_add_u32 s30, s30, 8192
    v_mfma_f32_16x16x32_bf16 v[156:159], a[176:179], v[196:199], v[156:159]
    v_exp_f32 v182, v182
    v_mfma_f32_16x16x32_bf16 a[48:51], a[180:183], v[196:199], a[48:51]
    s_cmp_eq_u32 s30, s101
    s_cselect_b32 s30, s100, s30
    v_mfma_f32_16x16x32_bf16 a[52:55], a[184:187], v[196:199], a[52:55]
    v_exp_f32 v183, v183
    v_mfma_f32_16x16x32_bf16 a[56:59], a[188:191], v[196:199], a[56:59]
    v_cvt_pk_bf16_f32 v195, v182, v183
    v_mfma_f32_16x16x32_bf16 a[60:63], a[192:195], v[196:199], a[60:63]
    v_mfma_f32_16x16x32_bf16 v[176:179], a[132:135], v[32:35], v[204:207]
    v_exp_f32 v184, v184
    v_mfma_f32_16x16x32_bf16 v[176:179], a[136:139], v[36:39], v[176:179]
    v_mfma_f32_16x16x32_bf16 v[176:179], a[140:143], v[40:43], v[176:179]
    v_exp_f32 v185, v185
    v_mfma_f32_16x16x32_bf16 v[176:179], a[144:147], v[44:47], v[176:179]
    v_cvt_pk_bf16_f32 v196, v184, v185
    v_mfma_f32_16x16x32_bf16 v[180:183], a[148:151], v[32:35], v[204:207]
    v_exp_f32 v186, v186
    v_mfma_f32_16x16x32_bf16 v[180:183], a[152:155], v[36:39], v[180:183]
    v_mfma_f32_16x16x32_bf16 v[180:183], a[156:159], v[40:43], v[180:183]
    v_exp_f32 v187, v187
    v_mfma_f32_16x16x32_bf16 v[180:183], a[160:163], v[44:47], v[180:183]
    v_cvt_pk_bf16_f32 v197, v186, v187
    v_mfma_f32_16x16x32_bf16 a[96:99], v[220:223], v[192:195], a[96:99]
    v_exp_f32 v188, v188
    v_mfma_f32_16x16x32_bf16 v[160:163], a[164:167], v[192:195], v[160:163]
    v_mfma_f32_16x16x32_bf16 v[164:167], a[168:171], v[192:195], v[164:167]
    v_exp_f32 v189, v189
    v_mfma_f32_16x16x32_bf16 v[168:171], a[172:175], v[192:195], v[168:171]
    v_cvt_pk_bf16_f32 v198, v188, v189
    s_add_u32 m0, s31, 49152
    v_mfma_f32_16x16x32_bf16 v[172:175], a[176:179], v[192:195], v[172:175]
    v_exp_f32 v190, v190
    v_mfma_f32_16x16x32_bf16 a[64:67], a[180:183], v[192:195], a[64:67]
    buffer_load_dwordx4 v236, s[12:15], s30 offen offset:0 nt lds
    v_mfma_f32_16x16x32_bf16 a[68:71], a[184:187], v[192:195], a[68:71]
    v_exp_f32 v191, v191
    v_mfma_f32_16x16x32_bf16 a[72:75], a[188:191], v[192:195], a[72:75]
    v_cvt_pk_bf16_f32 v199, v190, v191
    v_mfma_f32_16x16x32_bf16 a[76:79], a[192:195], v[192:195], a[76:79]
    buffer_load_dwordx4 v237, s[12:15], s30 offen offset:1024 nt lds
    v_mfma_f32_16x16x32_bf16 v[184:187], a[132:135], v[48:51], v[208:211]
    v_exp_f32 v176, v176
    v_mfma_f32_16x16x32_bf16 v[184:187], a[136:139], v[52:55], v[184:187]
    ds_read_b64_tr_b16 a[164:165], v228 offset:0
    ds_read_b64_tr_b16 a[166:167], v228 offset:4096
    v_mfma_f32_16x16x32_bf16 v[184:187], a[140:143], v[56:59], v[184:187]
    v_exp_f32 v177, v177
    v_mfma_f32_16x16x32_bf16 v[184:187], a[144:147], v[60:63], v[184:187]
    ds_read_b64_tr_b16 a[168:169], v229 offset:0
    v_cvt_pk_bf16_f32 v192, v176, v177
    v_mfma_f32_16x16x32_bf16 v[188:191], a[148:151], v[48:51], v[208:211]
    v_exp_f32 v178, v178
    v_mfma_f32_16x16x32_bf16 v[188:191], a[152:155], v[52:55], v[188:191]
    ds_read_b64_tr_b16 a[170:171], v229 offset:4096
    ds_read_b64_tr_b16 a[172:173], v230 offset:0
    v_mfma_f32_16x16x32_bf16 v[188:191], a[156:159], v[56:59], v[188:191]
    v_exp_f32 v179, v179
    v_mfma_f32_16x16x32_bf16 v[188:191], a[160:163], v[60:63], v[188:191]
    ds_read_b64_tr_b16 a[174:175], v230 offset:4096
    v_cvt_pk_bf16_f32 v193, v178, v179
    v_mfma_f32_16x16x32_bf16 a[80:83], v[220:223], v[196:199], a[80:83]
    v_exp_f32 v180, v180
    v_mfma_f32_16x16x32_bf16 v[96:99], a[196:199], v[196:199], v[96:99]
    v_mfma_f32_16x16x32_bf16 v[100:103], a[200:203], v[196:199], v[100:103]
    v_exp_f32 v181, v181
    v_mfma_f32_16x16x32_bf16 v[104:107], a[204:207], v[196:199], v[104:107]
    v_cvt_pk_bf16_f32 v194, v180, v181
    v_mfma_f32_16x16x32_bf16 v[108:111], a[208:211], v[196:199], v[108:111]
    v_exp_f32 v182, v182
    v_mfma_f32_16x16x32_bf16 a[0:3], a[212:215], v[196:199], a[0:3]
    buffer_load_dwordx4 v238, s[12:15], s30 offen offset:2048 nt lds
    v_mfma_f32_16x16x32_bf16 a[4:7], a[216:219], v[196:199], a[4:7]
    v_exp_f32 v183, v183
    v_mfma_f32_16x16x32_bf16 a[8:11], a[220:223], v[196:199], a[8:11]
    v_cvt_pk_bf16_f32 v195, v182, v183
    v_mfma_f32_16x16x32_bf16 a[12:15], a[224:227], v[196:199], a[12:15]
    buffer_load_dwordx4 v239, s[12:15], s30 offen offset:3072 nt lds
    v_mfma_f32_16x16x32_bf16 v[176:179], a[132:135], v[64:67], v[212:215]
    v_exp_f32 v184, v184
    v_mfma_f32_16x16x32_bf16 v[176:179], a[136:139], v[68:71], v[176:179]
    ds_read_b64_tr_b16 a[176:177], v231 offset:0
    ds_read_b64_tr_b16 a[178:179], v231 offset:4096
    v_mfma_f32_16x16x32_bf16 v[176:179], a[140:143], v[72:75], v[176:179]
    v_exp_f32 v185, v185
    v_mfma_f32_16x16x32_bf16 v[176:179], a[144:147], v[76:79], v[176:179]
    ds_read_b64_tr_b16 a[180:181], v232 offset:0
    v_cvt_pk_bf16_f32 v196, v184, v185
    v_mfma_f32_16x16x32_bf16 v[180:183], a[148:151], v[64:67], v[212:215]
    v_exp_f32 v186, v186
    v_mfma_f32_16x16x32_bf16 v[180:183], a[152:155], v[68:71], v[180:183]
    ds_read_b64_tr_b16 a[182:183], v232 offset:4096
    ds_read_b64_tr_b16 a[184:185], v233 offset:0
    v_mfma_f32_16x16x32_bf16 v[180:183], a[156:159], v[72:75], v[180:183]
    v_exp_f32 v187, v187
    v_mfma_f32_16x16x32_bf16 v[180:183], a[160:163], v[76:79], v[180:183]
    ds_read_b64_tr_b16 a[186:187], v233 offset:4096
    v_cvt_pk_bf16_f32 v197, v186, v187
    v_mfma_f32_16x16x32_bf16 a[84:87], v[220:223], v[192:195], a[84:87]
    v_exp_f32 v188, v188
    v_mfma_f32_16x16x32_bf16 v[112:115], a[196:199], v[192:195], v[112:115]
    v_mfma_f32_16x16x32_bf16 v[116:119], a[200:203], v[192:195], v[116:119]
    v_exp_f32 v189, v189
    v_mfma_f32_16x16x32_bf16 v[120:123], a[204:207], v[192:195], v[120:123]
    v_cvt_pk_bf16_f32 v198, v188, v189
    s_add_u32 m0, s31, 57344
    v_mfma_f32_16x16x32_bf16 v[124:127], a[208:211], v[192:195], v[124:127]
    v_exp_f32 v190, v190
    v_mfma_f32_16x16x32_bf16 a[16:19], a[212:215], v[192:195], a[16:19]
    buffer_load_dwordx4 v240, s[16:19], s30 offen offset:0 nt lds
    v_mfma_f32_16x16x32_bf16 a[20:23], a[216:219], v[192:195], a[20:23]
    v_exp_f32 v191, v191
    v_mfma_f32_16x16x32_bf16 a[24:27], a[220:223], v[192:195], a[24:27]
    v_cvt_pk_bf16_f32 v199, v190, v191
    v_mfma_f32_16x16x32_bf16 a[28:31], a[224:227], v[192:195], a[28:31]
    buffer_load_dwordx4 v241, s[16:19], s30 offen offset:1024 nt lds
    v_mfma_f32_16x16x32_bf16 v[184:187], a[132:135], v[80:83], v[216:219]
    v_exp_f32 v176, v176
    v_mfma_f32_16x16x32_bf16 v[184:187], a[136:139], v[84:87], v[184:187]
    ds_read_b64_tr_b16 a[188:189], v234 offset:0
    ds_read_b64_tr_b16 a[190:191], v234 offset:4096
    v_mfma_f32_16x16x32_bf16 v[184:187], a[140:143], v[88:91], v[184:187]
    v_exp_f32 v177, v177
    v_mfma_f32_16x16x32_bf16 v[184:187], a[144:147], v[92:95], v[184:187]
    ds_read_b64_tr_b16 a[192:193], v235 offset:0
    v_cvt_pk_bf16_f32 v192, v176, v177
    v_mfma_f32_16x16x32_bf16 v[188:191], a[148:151], v[80:83], v[216:219]
    v_exp_f32 v178, v178
    v_mfma_f32_16x16x32_bf16 v[188:191], a[152:155], v[84:87], v[188:191]
    ds_read_b64_tr_b16 a[194:195], v235 offset:4096
    v_mfma_f32_16x16x32_bf16 v[188:191], a[156:159], v[88:91], v[188:191]
    v_exp_f32 v179, v179
    v_mfma_f32_16x16x32_bf16 v[188:191], a[160:163], v[92:95], v[188:191]
    v_cvt_pk_bf16_f32 v193, v178, v179
    v_mfma_f32_16x16x32_bf16 a[88:91], v[220:223], v[196:199], a[88:91]
    v_exp_f32 v180, v180
    v_mfma_f32_16x16x32_bf16 v[128:131], a[196:199], v[196:199], v[128:131]
    buffer_load_dwordx4 v240, s[16:19], s30 offen offset:2048 nt lds
    v_mfma_f32_16x16x32_bf16 v[132:135], a[200:203], v[196:199], v[132:135]
    v_exp_f32 v181, v181
    v_mfma_f32_16x16x32_bf16 v[136:139], a[204:207], v[196:199], v[136:139]
    v_cvt_pk_bf16_f32 v194, v180, v181
    v_mfma_f32_16x16x32_bf16 v[140:143], a[208:211], v[196:199], v[140:143]
    v_exp_f32 v182, v182
    v_mfma_f32_16x16x32_bf16 a[32:35], a[212:215], v[196:199], a[32:35]
    buffer_load_dwordx4 v241, s[16:19], s30 offen offset:3072 nt lds
    v_mfma_f32_16x16x32_bf16 a[36:39], a[216:219], v[196:199], a[36:39]
    v_exp_f32 v183, v183
    v_mfma_f32_16x16x32_bf16 a[40:43], a[220:223], v[196:199], a[40:43]
    v_cvt_pk_bf16_f32 v195, v182, v183
    v_mfma_f32_16x16x32_bf16 a[44:47], a[224:227], v[196:199], a[44:47]
    s_waitcnt vmcnt(16) lgkmcnt(0)
    s_barrier
    v_mfma_f32_16x16x32_bf16 v[176:179], a[100:103], v[16:19], v[200:203]
    v_exp_f32 v184, v184
    v_mfma_f32_16x16x32_bf16 v[176:179], a[104:107], v[20:23], v[176:179]
    ds_read_b128 a[132:135], v224 offset:16384
    ds_read_b128 a[136:139], v225 offset:16384
    v_mfma_f32_16x16x32_bf16 v[176:179], a[108:111], v[24:27], v[176:179]
    v_exp_f32 v185, v185
    v_mfma_f32_16x16x32_bf16 v[176:179], a[112:115], v[28:31], v[176:179]
    ds_read_b128 a[140:143], v226 offset:16384
    v_cvt_pk_bf16_f32 v196, v184, v185
    v_mfma_f32_16x16x32_bf16 v[180:183], a[116:119], v[16:19], v[200:203]
    v_exp_f32 v186, v186
    v_mfma_f32_16x16x32_bf16 v[180:183], a[120:123], v[20:23], v[180:183]
    ds_read_b128 a[144:147], v227 offset:16384
    ds_read_b128 a[148:151], v224 offset:20480
    v_mfma_f32_16x16x32_bf16 v[180:183], a[124:127], v[24:27], v[180:183]
    v_exp_f32 v187, v187
    v_mfma_f32_16x16x32_bf16 v[180:183], a[128:131], v[28:31], v[180:183]
    ds_read_b128 a[152:155], v225 offset:20480
    v_cvt_pk_bf16_f32 v197, v186, v187
    v_mfma_f32_16x16x32_bf16 a[92:95], v[220:223], v[192:195], a[92:95]
    v_exp_f32 v188, v188
    v_mfma_f32_16x16x32_bf16 v[144:147], a[196:199], v[192:195], v[144:147]
    ds_read_b128 a[156:159], v226 offset:20480
    ds_read_b128 a[160:163], v227 offset:20480
    v_mfma_f32_16x16x32_bf16 v[148:151], a[200:203], v[192:195], v[148:151]
    v_exp_f32 v189, v189
    v_mfma_f32_16x16x32_bf16 v[152:155], a[204:207], v[192:195], v[152:155]
    v_cvt_pk_bf16_f32 v198, v188, v189
    s_add_u32 s30, s30, 8192
    v_mfma_f32_16x16x32_bf16 v[156:159], a[208:211], v[192:195], v[156:159]
    v_exp_f32 v190, v190
    v_mfma_f32_16x16x32_bf16 a[48:51], a[212:215], v[192:195], a[48:51]
    s_cmp_eq_u32 s30, s101
    s_cselect_b32 s30, s100, s30
    v_mfma_f32_16x16x32_bf16 a[52:55], a[216:219], v[192:195], a[52:55]
    v_exp_f32 v191, v191
    v_mfma_f32_16x16x32_bf16 a[56:59], a[220:223], v[192:195], a[56:59]
    v_cvt_pk_bf16_f32 v199, v190, v191
    v_mfma_f32_16x16x32_bf16 a[60:63], a[224:227], v[192:195], a[60:63]
    s_add_u32 s32, s32, 1
    s_cmp_lt_u32 s32, 7
    s_cbranch_scc1 L_loop

L_tail:
    v_mfma_f32_16x16x32_bf16 v[184:187], a[100:103], v[32:35], v[204:207]
    v_exp_f32 v176, v176
    v_mfma_f32_16x16x32_bf16 v[184:187], a[104:107], v[36:39], v[184:187]
    v_mfma_f32_16x16x32_bf16 v[184:187], a[108:111], v[40:43], v[184:187]
    v_exp_f32 v177, v177
    v_mfma_f32_16x16x32_bf16 v[184:187], a[112:115], v[44:47], v[184:187]
    v_cvt_pk_bf16_f32 v192, v176, v177
    v_mfma_f32_16x16x32_bf16 v[188:191], a[116:119], v[32:35], v[204:207]
    v_exp_f32 v178, v178
    v_mfma_f32_16x16x32_bf16 v[188:191], a[120:123], v[36:39], v[188:191]
    v_mfma_f32_16x16x32_bf16 v[188:191], a[124:127], v[40:43], v[188:191]
    v_exp_f32 v179, v179
    v_mfma_f32_16x16x32_bf16 v[188:191], a[128:131], v[44:47], v[188:191]
    v_cvt_pk_bf16_f32 v193, v178, v179
    v_mfma_f32_16x16x32_bf16 a[96:99], v[220:223], v[196:199], a[96:99]
    v_exp_f32 v180, v180
    v_mfma_f32_16x16x32_bf16 v[160:163], a[196:199], v[196:199], v[160:163]
    v_mfma_f32_16x16x32_bf16 v[164:167], a[200:203], v[196:199], v[164:167]
    v_exp_f32 v181, v181
    v_mfma_f32_16x16x32_bf16 v[168:171], a[204:207], v[196:199], v[168:171]
    v_cvt_pk_bf16_f32 v194, v180, v181
    s_add_u32 m0, s44, 0
    v_mfma_f32_16x16x32_bf16 v[172:175], a[208:211], v[196:199], v[172:175]
    v_exp_f32 v182, v182
    v_mfma_f32_16x16x32_bf16 a[64:67], a[212:215], v[196:199], a[64:67]
    buffer_load_dwordx4 v3, s[52:55], s43 offen offset:0 lds
    v_mfma_f32_16x16x32_bf16 a[68:71], a[216:219], v[196:199], a[68:71]
    v_exp_f32 v183, v183
    v_mfma_f32_16x16x32_bf16 a[72:75], a[220:223], v[196:199], a[72:75]
    v_cvt_pk_bf16_f32 v195, v182, v183
    v_mfma_f32_16x16x32_bf16 a[76:79], a[224:227], v[196:199], a[76:79]
    buffer_load_dwordx4 v4, s[52:55], s43 offen offset:1024 lds
    v_mfma_f32_16x16x32_bf16 v[176:179], a[100:103], v[48:51], v[208:211]
    v_exp_f32 v184, v184
    v_mfma_f32_16x16x32_bf16 v[176:179], a[104:107], v[52:55], v[176:179]
    ds_read_b64_tr_b16 a[196:197], v228 offset:16384
    ds_read_b64_tr_b16 a[198:199], v228 offset:20480
    v_mfma_f32_16x16x32_bf16 v[176:179], a[108:111], v[56:59], v[176:179]
    v_exp_f32 v185, v185
    v_mfma_f32_16x16x32_bf16 v[176:179], a[112:115], v[60:63], v[176:179]
    ds_read_b64_tr_b16 a[200:201], v229 offset:16384
    v_cvt_pk_bf16_f32 v196, v184, v185
    v_mfma_f32_16x16x32_bf16 v[180:183], a[116:119], v[48:51], v[208:211]
    v_exp_f32 v186, v186
    v_mfma_f32_16x16x32_bf16 v[180:183], a[120:123], v[52:55], v[180:183]
    ds_read_b64_tr_b16 a[202:203], v229 offset:20480
    ds_read_b64_tr_b16 a[204:205], v230 offset:16384
    v_mfma_f32_16x16x32_bf16 v[180:183], a[124:127], v[56:59], v[180:183]
    v_exp_f32 v187, v187
    v_mfma_f32_16x16x32_bf16 v[180:183], a[128:131], v[60:63], v[180:183]
    ds_read_b64_tr_b16 a[206:207], v230 offset:20480
    v_cvt_pk_bf16_f32 v197, v186, v187
    v_mfma_f32_16x16x32_bf16 a[80:83], v[220:223], v[192:195], a[80:83]
    v_exp_f32 v188, v188
    v_mfma_f32_16x16x32_bf16 v[96:99], a[164:167], v[192:195], v[96:99]
    v_mfma_f32_16x16x32_bf16 v[100:103], a[168:171], v[192:195], v[100:103]
    v_exp_f32 v189, v189
    v_mfma_f32_16x16x32_bf16 v[104:107], a[172:175], v[192:195], v[104:107]
    v_cvt_pk_bf16_f32 v198, v188, v189
    v_mfma_f32_16x16x32_bf16 v[108:111], a[176:179], v[192:195], v[108:111]
    v_exp_f32 v190, v190
    v_mfma_f32_16x16x32_bf16 a[0:3], a[180:183], v[192:195], a[0:3]
    buffer_load_dwordx4 v5, s[52:55], s43 offen offset:2048 lds
    v_mfma_f32_16x16x32_bf16 a[4:7], a[184:187], v[192:195], a[4:7]
    v_exp_f32 v191, v191
    v_mfma_f32_16x16x32_bf16 a[8:11], a[188:191], v[192:195], a[8:11]
    v_cvt_pk_bf16_f32 v199, v190, v191
    v_mfma_f32_16x16x32_bf16 a[12:15], a[192:195], v[192:195], a[12:15]
    buffer_load_dwordx4 v6, s[52:55], s43 offen offset:3072 lds
    s_add_u32 s43, s43, 36864
    v_mfma_f32_16x16x32_bf16 v[184:187], a[100:103], v[64:67], v[212:215]
    v_exp_f32 v176, v176
    v_mfma_f32_16x16x32_bf16 v[184:187], a[104:107], v[68:71], v[184:187]
    ds_read_b64_tr_b16 a[208:209], v231 offset:16384
    ds_read_b64_tr_b16 a[210:211], v231 offset:20480
    v_mfma_f32_16x16x32_bf16 v[184:187], a[108:111], v[72:75], v[184:187]
    v_exp_f32 v177, v177
    v_mfma_f32_16x16x32_bf16 v[184:187], a[112:115], v[76:79], v[184:187]
    ds_read_b64_tr_b16 a[212:213], v232 offset:16384
    v_cvt_pk_bf16_f32 v192, v176, v177
    v_mfma_f32_16x16x32_bf16 v[188:191], a[116:119], v[64:67], v[212:215]
    v_exp_f32 v178, v178
    v_mfma_f32_16x16x32_bf16 v[188:191], a[120:123], v[68:71], v[188:191]
    ds_read_b64_tr_b16 a[214:215], v232 offset:20480
    ds_read_b64_tr_b16 a[216:217], v233 offset:16384
    v_mfma_f32_16x16x32_bf16 v[188:191], a[124:127], v[72:75], v[188:191]
    v_exp_f32 v179, v179
    v_mfma_f32_16x16x32_bf16 v[188:191], a[128:131], v[76:79], v[188:191]
    ds_read_b64_tr_b16 a[218:219], v233 offset:20480
    v_cvt_pk_bf16_f32 v193, v178, v179
    v_mfma_f32_16x16x32_bf16 a[84:87], v[220:223], v[196:199], a[84:87]
    v_exp_f32 v180, v180
    v_mfma_f32_16x16x32_bf16 v[112:115], a[164:167], v[196:199], v[112:115]
    v_mfma_f32_16x16x32_bf16 v[116:119], a[168:171], v[196:199], v[116:119]
    v_exp_f32 v181, v181
    v_mfma_f32_16x16x32_bf16 v[120:123], a[172:175], v[196:199], v[120:123]
    v_cvt_pk_bf16_f32 v194, v180, v181
    s_add_u32 m0, s44, 65536
    v_mfma_f32_16x16x32_bf16 v[124:127], a[176:179], v[196:199], v[124:127]
    v_exp_f32 v182, v182
    v_mfma_f32_16x16x32_bf16 a[16:19], a[180:183], v[196:199], a[16:19]
    buffer_load_dwordx4 v3, s[52:55], s43 offen offset:0 lds
    v_mfma_f32_16x16x32_bf16 a[20:23], a[184:187], v[196:199], a[20:23]
    v_exp_f32 v183, v183
    v_mfma_f32_16x16x32_bf16 a[24:27], a[188:191], v[196:199], a[24:27]
    v_cvt_pk_bf16_f32 v195, v182, v183
    v_mfma_f32_16x16x32_bf16 a[28:31], a[192:195], v[196:199], a[28:31]
    buffer_load_dwordx4 v4, s[52:55], s43 offen offset:1024 lds
    v_mfma_f32_16x16x32_bf16 v[176:179], a[100:103], v[80:83], v[216:219]
    v_exp_f32 v184, v184
    v_mfma_f32_16x16x32_bf16 v[176:179], a[104:107], v[84:87], v[176:179]
    ds_read_b64_tr_b16 a[220:221], v234 offset:16384
    ds_read_b64_tr_b16 a[222:223], v234 offset:20480
    v_mfma_f32_16x16x32_bf16 v[176:179], a[108:111], v[88:91], v[176:179]
    v_exp_f32 v185, v185
    v_mfma_f32_16x16x32_bf16 v[176:179], a[112:115], v[92:95], v[176:179]
    ds_read_b64_tr_b16 a[224:225], v235 offset:16384
    v_cvt_pk_bf16_f32 v196, v184, v185
    v_mfma_f32_16x16x32_bf16 v[180:183], a[116:119], v[80:83], v[216:219]
    v_exp_f32 v186, v186
    v_mfma_f32_16x16x32_bf16 v[180:183], a[120:123], v[84:87], v[180:183]
    ds_read_b64_tr_b16 a[226:227], v235 offset:20480
    v_mfma_f32_16x16x32_bf16 v[180:183], a[124:127], v[88:91], v[180:183]
    v_exp_f32 v187, v187
    v_mfma_f32_16x16x32_bf16 v[180:183], a[128:131], v[92:95], v[180:183]
    v_cvt_pk_bf16_f32 v197, v186, v187
    v_mfma_f32_16x16x32_bf16 a[88:91], v[220:223], v[192:195], a[88:91]
    v_exp_f32 v188, v188
    v_mfma_f32_16x16x32_bf16 v[128:131], a[164:167], v[192:195], v[128:131]
    buffer_load_dwordx4 v5, s[52:55], s43 offen offset:2048 lds
    v_mfma_f32_16x16x32_bf16 v[132:135], a[168:171], v[192:195], v[132:135]
    v_exp_f32 v189, v189
    v_mfma_f32_16x16x32_bf16 v[136:139], a[172:175], v[192:195], v[136:139]
    v_cvt_pk_bf16_f32 v198, v188, v189
    v_mfma_f32_16x16x32_bf16 v[140:143], a[176:179], v[192:195], v[140:143]
    v_exp_f32 v190, v190
    v_mfma_f32_16x16x32_bf16 a[32:35], a[180:183], v[192:195], a[32:35]
    buffer_load_dwordx4 v6, s[52:55], s43 offen offset:3072 lds
    s_add_u32 s43, s43, 36864
    v_mfma_f32_16x16x32_bf16 a[36:39], a[184:187], v[192:195], a[36:39]
    v_exp_f32 v191, v191
    v_mfma_f32_16x16x32_bf16 a[40:43], a[188:191], v[192:195], a[40:43]
    v_cvt_pk_bf16_f32 v199, v190, v191
    v_mfma_f32_16x16x32_bf16 a[44:47], a[192:195], v[192:195], a[44:47]
    s_waitcnt vmcnt(16) lgkmcnt(0)
    s_barrier
    v_mfma_f32_16x16x32_bf16 v[184:187], a[132:135], v[16:19], v[200:203]
    v_exp_f32 v176, v176
    v_mfma_f32_16x16x32_bf16 v[184:187], a[136:139], v[20:23], v[184:187]
    ds_read_b128 a[100:103], v224 offset:32768
    ds_read_b128 a[104:107], v225 offset:32768
    v_mfma_f32_16x16x32_bf16 v[184:187], a[140:143], v[24:27], v[184:187]
    v_exp_f32 v177, v177
    v_mfma_f32_16x16x32_bf16 v[184:187], a[144:147], v[28:31], v[184:187]
    ds_read_b128 a[108:111], v226 offset:32768
    v_cvt_pk_bf16_f32 v192, v176, v177
    v_mfma_f32_16x16x32_bf16 v[188:191], a[148:151], v[16:19], v[200:203]
    v_exp_f32 v178, v178
    v_mfma_f32_16x16x32_bf16 v[188:191], a[152:155], v[20:23], v[188:191]
    ds_read_b128 a[112:115], v227 offset:32768
    ds_read_b128 a[116:119], v224 offset:36864
    v_mfma_f32_16x16x32_bf16 v[188:191], a[156:159], v[24:27], v[188:191]
    v_exp_f32 v179, v179
    v_mfma_f32_16x16x32_bf16 v[188:191], a[160:163], v[28:31], v[188:191]
    ds_read_b128 a[120:123], v225 offset:36864
    v_cvt_pk_bf16_f32 v193, v178, v179
    v_mfma_f32_16x16x32_bf16 a[92:95], v[220:223], v[196:199], a[92:95]
    v_exp_f32 v180, v180
    v_mfma_f32_16x16x32_bf16 v[144:147], a[164:167], v[196:199], v[144:147]
    ds_read_b128 a[124:127], v226 offset:36864
    ds_read_b128 a[128:131], v227 offset:36864
    v_mfma_f32_16x16x32_bf16 v[148:151], a[168:171], v[196:199], v[148:151]
    v_exp_f32 v181, v181
    v_mfma_f32_16x16x32_bf16 v[152:155], a[172:175], v[196:199], v[152:155]
    v_cvt_pk_bf16_f32 v194, v180, v181
    v_mfma_f32_16x16x32_bf16 v[156:159], a[176:179], v[196:199], v[156:159]
    v_exp_f32 v182, v182
    v_mfma_f32_16x16x32_bf16 a[48:51], a[180:183], v[196:199], a[48:51]
    v_mfma_f32_16x16x32_bf16 a[52:55], a[184:187], v[196:199], a[52:55]
    v_exp_f32 v183, v183
    v_mfma_f32_16x16x32_bf16 a[56:59], a[188:191], v[196:199], a[56:59]
    v_cvt_pk_bf16_f32 v195, v182, v183
    v_mfma_f32_16x16x32_bf16 a[60:63], a[192:195], v[196:199], a[60:63]
    v_mfma_f32_16x16x32_bf16 v[176:179], a[132:135], v[32:35], v[204:207]
    v_exp_f32 v184, v184
    v_mfma_f32_16x16x32_bf16 v[176:179], a[136:139], v[36:39], v[176:179]
    v_mfma_f32_16x16x32_bf16 v[176:179], a[140:143], v[40:43], v[176:179]
    v_exp_f32 v185, v185
    v_mfma_f32_16x16x32_bf16 v[176:179], a[144:147], v[44:47], v[176:179]
    v_cvt_pk_bf16_f32 v196, v184, v185
    v_mfma_f32_16x16x32_bf16 v[180:183], a[148:151], v[32:35], v[204:207]
    v_exp_f32 v186, v186
    v_mfma_f32_16x16x32_bf16 v[180:183], a[152:155], v[36:39], v[180:183]
    v_mfma_f32_16x16x32_bf16 v[180:183], a[156:159], v[40:43], v[180:183]
    v_exp_f32 v187, v187
    v_mfma_f32_16x16x32_bf16 v[180:183], a[160:163], v[44:47], v[180:183]
    v_cvt_pk_bf16_f32 v197, v186, v187
    v_mfma_f32_16x16x32_bf16 a[96:99], v[220:223], v[192:195], a[96:99]
    v_exp_f32 v188, v188
    v_mfma_f32_16x16x32_bf16 v[160:163], a[164:167], v[192:195], v[160:163]
    v_mfma_f32_16x16x32_bf16 v[164:167], a[168:171], v[192:195], v[164:167]
    v_exp_f32 v189, v189
    v_mfma_f32_16x16x32_bf16 v[168:171], a[172:175], v[192:195], v[168:171]
    v_cvt_pk_bf16_f32 v198, v188, v189
    s_add_u32 m0, s44, 16384
    v_mfma_f32_16x16x32_bf16 v[172:175], a[176:179], v[192:195], v[172:175]
    v_exp_f32 v190, v190
    v_mfma_f32_16x16x32_bf16 a[64:67], a[180:183], v[192:195], a[64:67]
    buffer_load_dwordx4 v3, s[52:55], s43 offen offset:0 lds
    v_mfma_f32_16x16x32_bf16 a[68:71], a[184:187], v[192:195], a[68:71]
    v_exp_f32 v191, v191
    v_mfma_f32_16x16x32_bf16 a[72:75], a[188:191], v[192:195], a[72:75]
    v_cvt_pk_bf16_f32 v199, v190, v191
    v_mfma_f32_16x16x32_bf16 a[76:79], a[192:195], v[192:195], a[76:79]
    buffer_load_dwordx4 v4, s[52:55], s43 offen offset:1024 lds
    v_mfma_f32_16x16x32_bf16 v[184:187], a[132:135], v[48:51], v[208:211]
    v_exp_f32 v176, v176
    v_mfma_f32_16x16x32_bf16 v[184:187], a[136:139], v[52:55], v[184:187]
    ds_read_b64_tr_b16 a[164:165], v228 offset:32768
    ds_read_b64_tr_b16 a[166:167], v228 offset:36864
    v_mfma_f32_16x16x32_bf16 v[184:187], a[140:143], v[56:59], v[184:187]
    v_exp_f32 v177, v177
    v_mfma_f32_16x16x32_bf16 v[184:187], a[144:147], v[60:63], v[184:187]
    ds_read_b64_tr_b16 a[168:169], v229 offset:32768
    v_cvt_pk_bf16_f32 v192, v176, v177
    v_mfma_f32_16x16x32_bf16 v[188:191], a[148:151], v[48:51], v[208:211]
    v_exp_f32 v178, v178
    v_mfma_f32_16x16x32_bf16 v[188:191], a[152:155], v[52:55], v[188:191]
    ds_read_b64_tr_b16 a[170:171], v229 offset:36864
    ds_read_b64_tr_b16 a[172:173], v230 offset:32768
    v_mfma_f32_16x16x32_bf16 v[188:191], a[156:159], v[56:59], v[188:191]
    v_exp_f32 v179, v179
    v_mfma_f32_16x16x32_bf16 v[188:191], a[160:163], v[60:63], v[188:191]
    ds_read_b64_tr_b16 a[174:175], v230 offset:36864
    v_cvt_pk_bf16_f32 v193, v178, v179
    v_mfma_f32_16x16x32_bf16 a[80:83], v[220:223], v[196:199], a[80:83]
    v_exp_f32 v180, v180
    v_mfma_f32_16x16x32_bf16 v[96:99], a[196:199], v[196:199], v[96:99]
    v_mfma_f32_16x16x32_bf16 v[100:103], a[200:203], v[196:199], v[100:103]
    v_exp_f32 v181, v181
    v_mfma_f32_16x16x32_bf16 v[104:107], a[204:207], v[196:199], v[104:107]
    v_cvt_pk_bf16_f32 v194, v180, v181
    v_mfma_f32_16x16x32_bf16 v[108:111], a[208:211], v[196:199], v[108:111]
    v_exp_f32 v182, v182
    v_mfma_f32_16x16x32_bf16 a[0:3], a[212:215], v[196:199], a[0:3]
    buffer_load_dwordx4 v5, s[52:55], s43 offen offset:2048 lds
    v_mfma_f32_16x16x32_bf16 a[4:7], a[216:219], v[196:199], a[4:7]
    v_exp_f32 v183, v183
    v_mfma_f32_16x16x32_bf16 a[8:11], a[220:223], v[196:199], a[8:11]
    v_cvt_pk_bf16_f32 v195, v182, v183
    v_mfma_f32_16x16x32_bf16 a[12:15], a[224:227], v[196:199], a[12:15]
    buffer_load_dwordx4 v6, s[52:55], s43 offen offset:3072 lds
    s_add_u32 s43, s43, 36864
    v_mfma_f32_16x16x32_bf16 v[176:179], a[132:135], v[64:67], v[212:215]
    v_exp_f32 v184, v184
    v_mfma_f32_16x16x32_bf16 v[176:179], a[136:139], v[68:71], v[176:179]
    ds_read_b64_tr_b16 a[176:177], v231 offset:32768
    ds_read_b64_tr_b16 a[178:179], v231 offset:36864
    v_mfma_f32_16x16x32_bf16 v[176:179], a[140:143], v[72:75], v[176:179]
    v_exp_f32 v185, v185
    v_mfma_f32_16x16x32_bf16 v[176:179], a[144:147], v[76:79], v[176:179]
    ds_read_b64_tr_b16 a[180:181], v232 offset:32768
    v_cvt_pk_bf16_f32 v196, v184, v185
    v_mfma_f32_16x16x32_bf16 v[180:183], a[148:151], v[64:67], v[212:215]
    v_exp_f32 v186, v186
    v_mfma_f32_16x16x32_bf16 v[180:183], a[152:155], v[68:71], v[180:183]
    ds_read_b64_tr_b16 a[182:183], v232 offset:36864
    ds_read_b64_tr_b16 a[184:185], v233 offset:32768
    v_mfma_f32_16x16x32_bf16 v[180:183], a[156:159], v[72:75], v[180:183]
    v_exp_f32 v187, v187
    v_mfma_f32_16x16x32_bf16 v[180:183], a[160:163], v[76:79], v[180:183]
    ds_read_b64_tr_b16 a[186:187], v233 offset:36864
    v_cvt_pk_bf16_f32 v197, v186, v187
    v_mfma_f32_16x16x32_bf16 a[84:87], v[220:223], v[192:195], a[84:87]
    v_exp_f32 v188, v188
    v_mfma_f32_16x16x32_bf16 v[112:115], a[196:199], v[192:195], v[112:115]
    v_mfma_f32_16x16x32_bf16 v[116:119], a[200:203], v[192:195], v[116:119]
    v_exp_f32 v189, v189
    v_mfma_f32_16x16x32_bf16 v[120:123], a[204:207], v[192:195], v[120:123]
    v_cvt_pk_bf16_f32 v198, v188, v189
    s_add_u32 m0, s44, 81920
    v_mfma_f32_16x16x32_bf16 v[124:127], a[208:211], v[192:195], v[124:127]
    v_exp_f32 v190, v190
    v_mfma_f32_16x16x32_bf16 a[16:19], a[212:215], v[192:195], a[16:19]
    buffer_load_dwordx4 v3, s[52:55], s43 offen offset:0 lds
    v_mfma_f32_16x16x32_bf16 a[20:23], a[216:219], v[192:195], a[20:23]
    v_exp_f32 v191, v191
    v_mfma_f32_16x16x32_bf16 a[24:27], a[220:223], v[192:195], a[24:27]
    v_cvt_pk_bf16_f32 v199, v190, v191
    v_mfma_f32_16x16x32_bf16 a[28:31], a[224:227], v[192:195], a[28:31]
    buffer_load_dwordx4 v4, s[52:55], s43 offen offset:1024 lds
    v_mfma_f32_16x16x32_bf16 v[184:187], a[132:135], v[80:83], v[216:219]
    v_exp_f32 v176, v176
    v_mfma_f32_16x16x32_bf16 v[184:187], a[136:139], v[84:87], v[184:187]
    ds_read_b64_tr_b16 a[188:189], v234 offset:32768
    ds_read_b64_tr_b16 a[190:191], v234 offset:36864
    v_mfma_f32_16x16x32_bf16 v[184:187], a[140:143], v[88:91], v[184:187]
    v_exp_f32 v177, v177
    v_mfma_f32_16x16x32_bf16 v[184:187], a[144:147], v[92:95], v[184:187]
    ds_read_b64_tr_b16 a[192:193], v235 offset:32768
    v_cvt_pk_bf16_f32 v192, v176, v177
    v_mfma_f32_16x16x32_bf16 v[188:191], a[148:151], v[80:83], v[216:219]
    v_exp_f32 v178, v178
    v_mfma_f32_16x16x32_bf16 v[188:191], a[152:155], v[84:87], v[188:191]
    ds_read_b64_tr_b16 a[194:195], v235 offset:36864
    v_mfma_f32_16x16x32_bf16 v[188:191], a[156:159], v[88:91], v[188:191]
    v_exp_f32 v179, v179
    v_mfma_f32_16x16x32_bf16 v[188:191], a[160:163], v[92:95], v[188:191]
    v_cvt_pk_bf16_f32 v193, v178, v179
    v_mfma_f32_16x16x32_bf16 a[88:91], v[220:223], v[196:199], a[88:91]
    v_exp_f32 v180, v180
    v_mfma_f32_16x16x32_bf16 v[128:131], a[196:199], v[196:199], v[128:131]
    buffer_load_dwordx4 v5, s[52:55], s43 offen offset:2048 lds
    v_mfma_f32_16x16x32_bf16 v[132:135], a[200:203], v[196:199], v[132:135]
    v_exp_f32 v181, v181
    v_mfma_f32_16x16x32_bf16 v[136:139], a[204:207], v[196:199], v[136:139]
    v_cvt_pk_bf16_f32 v194, v180, v181
    v_mfma_f32_16x16x32_bf16 v[140:143], a[208:211], v[196:199], v[140:143]
    v_exp_f32 v182, v182
    v_mfma_f32_16x16x32_bf16 a[32:35], a[212:215], v[196:199], a[32:35]
    buffer_load_dwordx4 v6, s[52:55], s43 offen offset:3072 lds
    s_add_u32 s43, s43, 36864
    v_mfma_f32_16x16x32_bf16 a[36:39], a[216:219], v[196:199], a[36:39]
    v_exp_f32 v183, v183
    v_mfma_f32_16x16x32_bf16 a[40:43], a[220:223], v[196:199], a[40:43]
    v_cvt_pk_bf16_f32 v195, v182, v183
    v_mfma_f32_16x16x32_bf16 a[44:47], a[224:227], v[196:199], a[44:47]
    s_waitcnt vmcnt(16) lgkmcnt(0)
    s_barrier
    v_mfma_f32_16x16x32_bf16 v[176:179], a[100:103], v[16:19], v[200:203]
    v_exp_f32 v184, v184
    v_mfma_f32_16x16x32_bf16 v[176:179], a[104:107], v[20:23], v[176:179]
    ds_read_b128 a[132:135], v224 offset:49152
    ds_read_b128 a[136:139], v225 offset:49152
    v_mfma_f32_16x16x32_bf16 v[176:179], a[108:111], v[24:27], v[176:179]
    v_exp_f32 v185, v185
    v_mfma_f32_16x16x32_bf16 v[176:179], a[112:115], v[28:31], v[176:179]
    ds_read_b128 a[140:143], v226 offset:49152
    v_cvt_pk_bf16_f32 v196, v184, v185
    v_mfma_f32_16x16x32_bf16 v[180:183], a[116:119], v[16:19], v[200:203]
    v_exp_f32 v186, v186
    v_mfma_f32_16x16x32_bf16 v[180:183], a[120:123], v[20:23], v[180:183]
    ds_read_b128 a[144:147], v227 offset:49152
    ds_read_b128 a[148:151], v224 offset:53248
    v_mfma_f32_16x16x32_bf16 v[180:183], a[124:127], v[24:27], v[180:183]
    v_exp_f32 v187, v187
    v_mfma_f32_16x16x32_bf16 v[180:183], a[128:131], v[28:31], v[180:183]
    ds_read_b128 a[152:155], v225 offset:53248
    v_cvt_pk_bf16_f32 v197, v186, v187
    v_mfma_f32_16x16x32_bf16 a[92:95], v[220:223], v[192:195], a[92:95]
    v_exp_f32 v188, v188
    v_mfma_f32_16x16x32_bf16 v[144:147], a[196:199], v[192:195], v[144:147]
    ds_read_b128 a[156:159], v226 offset:53248
    ds_read_b128 a[160:163], v227 offset:53248
    v_mfma_f32_16x16x32_bf16 v[148:151], a[200:203], v[192:195], v[148:151]
    v_exp_f32 v189, v189
    v_mfma_f32_16x16x32_bf16 v[152:155], a[204:207], v[192:195], v[152:155]
    v_cvt_pk_bf16_f32 v198, v188, v189
    v_mfma_f32_16x16x32_bf16 v[156:159], a[208:211], v[192:195], v[156:159]
    v_exp_f32 v190, v190
    v_mfma_f32_16x16x32_bf16 a[48:51], a[212:215], v[192:195], a[48:51]
    v_mfma_f32_16x16x32_bf16 a[52:55], a[216:219], v[192:195], a[52:55]
    v_exp_f32 v191, v191
    v_mfma_f32_16x16x32_bf16 a[56:59], a[220:223], v[192:195], a[56:59]
    v_cvt_pk_bf16_f32 v199, v190, v191
    v_mfma_f32_16x16x32_bf16 a[60:63], a[224:227], v[192:195], a[60:63]
    v_mfma_f32_16x16x32_bf16 v[184:187], a[100:103], v[32:35], v[204:207]
    v_exp_f32 v176, v176
    s_waitcnt vmcnt(12)
    v_mfma_f32_16x16x32_bf16 v[184:187], a[104:107], v[36:39], v[184:187]
    ds_read_b64_tr_b16 a[228:229], v10 offset:0
    ds_read_b64_tr_b16 a[230:231], v10 offset:2048
    v_mfma_f32_16x16x32_bf16 v[184:187], a[108:111], v[40:43], v[184:187]
    v_exp_f32 v177, v177
    v_mfma_f32_16x16x32_bf16 v[184:187], a[112:115], v[44:47], v[184:187]
    v_cvt_pk_bf16_f32 v192, v176, v177
    ds_read_b64_tr_b16 a[232:233], v11 offset:0
    v_mfma_f32_16x16x32_bf16 v[188:191], a[116:119], v[32:35], v[204:207]
    v_exp_f32 v178, v178
    v_mfma_f32_16x16x32_bf16 v[188:191], a[120:123], v[36:39], v[188:191]
    ds_read_b64_tr_b16 a[234:235], v11 offset:2048
    ds_read_b64_tr_b16 a[236:237], v12 offset:0
    v_mfma_f32_16x16x32_bf16 v[188:191], a[124:127], v[40:43], v[188:191]
    v_exp_f32 v179, v179
    v_mfma_f32_16x16x32_bf16 v[188:191], a[128:131], v[44:47], v[188:191]
    v_cvt_pk_bf16_f32 v193, v178, v179
    ds_read_b64_tr_b16 a[238:239], v12 offset:2048
    v_mfma_f32_16x16x32_bf16 a[96:99], v[220:223], v[196:199], a[96:99]
    v_exp_f32 v180, v180
    v_mfma_f32_16x16x32_bf16 v[160:163], a[196:199], v[196:199], v[160:163]
    ds_read_b64_tr_b16 a[240:241], v13 offset:0
    ds_read_b64_tr_b16 a[242:243], v13 offset:2048
    v_mfma_f32_16x16x32_bf16 v[164:167], a[200:203], v[196:199], v[164:167]
    v_exp_f32 v181, v181
    v_mfma_f32_16x16x32_bf16 v[168:171], a[204:207], v[196:199], v[168:171]
    v_cvt_pk_bf16_f32 v194, v180, v181
    s_add_u32 m0, s44, 32768
    v_mfma_f32_16x16x32_bf16 v[172:175], a[208:211], v[196:199], v[172:175]
    v_exp_f32 v182, v182
    v_mfma_f32_16x16x32_bf16 a[64:67], a[212:215], v[196:199], a[64:67]
    buffer_load_dwordx4 v3, s[52:55], s43 offen offset:0 lds
    v_mfma_f32_16x16x32_bf16 a[68:71], a[216:219], v[196:199], a[68:71]
    v_exp_f32 v183, v183
    v_mfma_f32_16x16x32_bf16 a[72:75], a[220:223], v[196:199], a[72:75]
    v_cvt_pk_bf16_f32 v195, v182, v183
    v_mfma_f32_16x16x32_bf16 a[76:79], a[224:227], v[196:199], a[76:79]
    buffer_load_dwordx4 v4, s[52:55], s43 offen offset:1024 lds
    v_mfma_f32_16x16x32_bf16 v[176:179], a[100:103], v[48:51], v[208:211]
    v_exp_f32 v184, v184
    v_mfma_f32_16x16x32_bf16 v[176:179], a[104:107], v[52:55], v[176:179]
    ds_read_b64_tr_b16 a[196:197], v228 offset:49152
    ds_read_b64_tr_b16 a[198:199], v228 offset:53248
    v_mfma_f32_16x16x32_bf16 v[176:179], a[108:111], v[56:59], v[176:179]
    v_exp_f32 v185, v185
    v_mfma_f32_16x16x32_bf16 v[176:179], a[112:115], v[60:63], v[176:179]
    ds_read_b64_tr_b16 a[200:201], v229 offset:49152
    v_cvt_pk_bf16_f32 v196, v184, v185
    v_mfma_f32_16x16x32_bf16 v[180:183], a[116:119], v[48:51], v[208:211]
    v_exp_f32 v186, v186
    v_mfma_f32_16x16x32_bf16 v[180:183], a[120:123], v[52:55], v[180:183]
    ds_read_b64_tr_b16 a[202:203], v229 offset:53248
    ds_read_b64_tr_b16 a[204:205], v230 offset:49152
    v_mfma_f32_16x16x32_bf16 v[180:183], a[124:127], v[56:59], v[180:183]
    v_exp_f32 v187, v187
    v_mfma_f32_16x16x32_bf16 v[180:183], a[128:131], v[60:63], v[180:183]
    ds_read_b64_tr_b16 a[206:207], v230 offset:53248
    v_cvt_pk_bf16_f32 v197, v186, v187
    v_mfma_f32_16x16x32_bf16 a[80:83], v[220:223], v[192:195], a[80:83]
    v_exp_f32 v188, v188
    v_mfma_f32_16x16x32_bf16 v[96:99], a[164:167], v[192:195], v[96:99]
    v_mfma_f32_16x16x32_bf16 v[100:103], a[168:171], v[192:195], v[100:103]
    v_exp_f32 v189, v189
    v_mfma_f32_16x16x32_bf16 v[104:107], a[172:175], v[192:195], v[104:107]
    v_cvt_pk_bf16_f32 v198, v188, v189
    v_mfma_f32_16x16x32_bf16 v[108:111], a[176:179], v[192:195], v[108:111]
    v_exp_f32 v190, v190
    v_mfma_f32_16x16x32_bf16 a[0:3], a[180:183], v[192:195], a[0:3]
    buffer_load_dwordx4 v5, s[52:55], s43 offen offset:2048 lds
    v_mfma_f32_16x16x32_bf16 a[4:7], a[184:187], v[192:195], a[4:7]
    v_exp_f32 v191, v191
    v_mfma_f32_16x16x32_bf16 a[8:11], a[188:191], v[192:195], a[8:11]
    v_cvt_pk_bf16_f32 v199, v190, v191
    v_mfma_f32_16x16x32_bf16 a[12:15], a[192:195], v[192:195], a[12:15]
    buffer_load_dwordx4 v6, s[52:55], s43 offen offset:3072 lds
    s_add_u32 s43, s43, 36864
    v_mfma_f32_16x16x32_bf16 v[184:187], a[100:103], v[64:67], v[212:215]
    v_exp_f32 v176, v176
    v_mfma_f32_16x16x32_bf16 v[184:187], a[104:107], v[68:71], v[184:187]
    ds_read_b64_tr_b16 a[208:209], v231 offset:49152
    ds_read_b64_tr_b16 a[210:211], v231 offset:53248
    v_mfma_f32_16x16x32_bf16 v[184:187], a[108:111], v[72:75], v[184:187]
    v_exp_f32 v177, v177
    v_mfma_f32_16x16x32_bf16 v[184:187], a[112:115], v[76:79], v[184:187]
    ds_read_b64_tr_b16 a[212:213], v232 offset:49152
    v_cvt_pk_bf16_f32 v192, v176, v177
    v_mfma_f32_16x16x32_bf16 v[188:191], a[116:119], v[64:67], v[212:215]
    v_exp_f32 v178, v178
    v_mfma_f32_16x16x32_bf16 v[188:191], a[120:123], v[68:71], v[188:191]
    ds_read_b64_tr_b16 a[214:215], v232 offset:53248
    ds_read_b64_tr_b16 a[216:217], v233 offset:49152
    v_mfma_f32_16x16x32_bf16 v[188:191], a[124:127], v[72:75], v[188:191]
    v_exp_f32 v179, v179
    v_mfma_f32_16x16x32_bf16 v[188:191], a[128:131], v[76:79], v[188:191]
    ds_read_b64_tr_b16 a[218:219], v233 offset:53248
    v_cvt_pk_bf16_f32 v193, v178, v179
    v_mfma_f32_16x16x32_bf16 a[84:87], v[220:223], v[196:199], a[84:87]
    v_exp_f32 v180, v180
    v_mfma_f32_16x16x32_bf16 v[112:115], a[164:167], v[196:199], v[112:115]
    v_mfma_f32_16x16x32_bf16 v[116:119], a[168:171], v[196:199], v[116:119]
    v_exp_f32 v181, v181
    v_mfma_f32_16x16x32_bf16 v[120:123], a[172:175], v[196:199], v[120:123]
    v_cvt_pk_bf16_f32 v194, v180, v181
    s_add_u32 m0, s44, 98304
    v_mfma_f32_16x16x32_bf16 v[124:127], a[176:179], v[196:199], v[124:127]
    v_exp_f32 v182, v182
    v_mfma_f32_16x16x32_bf16 a[16:19], a[180:183], v[196:199], a[16:19]
    buffer_load_dwordx4 v3, s[52:55], s43 offen offset:0 lds
    v_mfma_f32_16x16x32_bf16 a[20:23], a[184:187], v[196:199], a[20:23]
    v_exp_f32 v183, v183
    v_mfma_f32_16x16x32_bf16 a[24:27], a[188:191], v[196:199], a[24:27]
    v_cvt_pk_bf16_f32 v195, v182, v183
    v_mfma_f32_16x16x32_bf16 a[28:31], a[192:195], v[196:199], a[28:31]
    buffer_load_dwordx4 v4, s[52:55], s43 offen offset:1024 lds
    v_mfma_f32_16x16x32_bf16 v[176:179], a[100:103], v[80:83], v[216:219]
    v_exp_f32 v184, v184
    v_mfma_f32_16x16x32_bf16 v[176:179], a[104:107], v[84:87], v[176:179]
    ds_read_b64_tr_b16 a[220:221], v234 offset:49152
    ds_read_b64_tr_b16 a[222:223], v234 offset:53248
    v_mfma_f32_16x16x32_bf16 v[176:179], a[108:111], v[88:91], v[176:179]
    v_exp_f32 v185, v185
    v_mfma_f32_16x16x32_bf16 v[176:179], a[112:115], v[92:95], v[176:179]
    ds_read_b64_tr_b16 a[224:225], v235 offset:49152
    v_cvt_pk_bf16_f32 v196, v184, v185
    v_mfma_f32_16x16x32_bf16 v[180:183], a[116:119], v[80:83], v[216:219]
    v_exp_f32 v186, v186
    v_mfma_f32_16x16x32_bf16 v[180:183], a[120:123], v[84:87], v[180:183]
    ds_read_b64_tr_b16 a[226:227], v235 offset:53248
    v_mfma_f32_16x16x32_bf16 v[180:183], a[124:127], v[88:91], v[180:183]
    v_exp_f32 v187, v187
    v_mfma_f32_16x16x32_bf16 v[180:183], a[128:131], v[92:95], v[180:183]
    v_cvt_pk_bf16_f32 v197, v186, v187
    v_mfma_f32_16x16x32_bf16 a[88:91], v[220:223], v[192:195], a[88:91]
    v_exp_f32 v188, v188
    v_mfma_f32_16x16x32_bf16 v[128:131], a[164:167], v[192:195], v[128:131]
    buffer_load_dwordx4 v5, s[52:55], s43 offen offset:2048 lds
    v_mfma_f32_16x16x32_bf16 v[132:135], a[168:171], v[192:195], v[132:135]
    v_exp_f32 v189, v189
    v_mfma_f32_16x16x32_bf16 v[136:139], a[172:175], v[192:195], v[136:139]
    v_cvt_pk_bf16_f32 v198, v188, v189
    v_mfma_f32_16x16x32_bf16 v[140:143], a[176:179], v[192:195], v[140:143]
    v_exp_f32 v190, v190
    v_mfma_f32_16x16x32_bf16 a[32:35], a[180:183], v[192:195], a[32:35]
    buffer_load_dwordx4 v6, s[52:55], s43 offen offset:3072 lds
    s_add_u32 s43, s43, 36864
    v_mfma_f32_16x16x32_bf16 a[36:39], a[184:187], v[192:195], a[36:39]
    v_exp_f32 v191, v191
    v_mfma_f32_16x16x32_bf16 a[40:43], a[188:191], v[192:195], a[40:43]
    v_cvt_pk_bf16_f32 v199, v190, v191
    v_mfma_f32_16x16x32_bf16 a[44:47], a[192:195], v[192:195], a[44:47]
    s_waitcnt lgkmcnt(0)
    s_barrier
    v_mfma_f32_16x16x32_bf16 v[184:187], a[132:135], v[16:19], v[200:203]
    v_exp_f32 v176, v176
    s_waitcnt vmcnt(16)
    v_mfma_f32_16x16x32_bf16 v[184:187], a[136:139], v[20:23], v[184:187]
    ds_read_b64_tr_b16 a[100:101], v14 offset:0
    ds_read_b64_tr_b16 a[102:103], v14 offset:2048
    v_mfma_f32_16x16x32_bf16 v[184:187], a[140:143], v[24:27], v[184:187]
    v_exp_f32 v177, v177
    v_mfma_f32_16x16x32_bf16 v[184:187], a[144:147], v[28:31], v[184:187]
    v_cvt_pk_bf16_f32 v192, v176, v177
    ds_read_b64_tr_b16 a[104:105], v15 offset:0
    v_mfma_f32_16x16x32_bf16 v[188:191], a[148:151], v[16:19], v[200:203]
    v_exp_f32 v178, v178
    v_mfma_f32_16x16x32_bf16 v[188:191], a[152:155], v[20:23], v[188:191]
    ds_read_b64_tr_b16 a[106:107], v15 offset:2048
    ds_read_b64_tr_b16 a[108:109], v242 offset:0
    v_mfma_f32_16x16x32_bf16 v[188:191], a[156:159], v[24:27], v[188:191]
    v_exp_f32 v179, v179
    v_mfma_f32_16x16x32_bf16 v[188:191], a[160:163], v[28:31], v[188:191]
    v_cvt_pk_bf16_f32 v193, v178, v179
    ds_read_b64_tr_b16 a[110:111], v242 offset:2048
    v_mfma_f32_16x16x32_bf16 a[92:95], v[220:223], v[196:199], a[92:95]
    v_exp_f32 v180, v180
    v_mfma_f32_16x16x32_bf16 v[144:147], a[164:167], v[196:199], v[144:147]
    ds_read_b64_tr_b16 a[112:113], v243 offset:0
    ds_read_b64_tr_b16 a[114:115], v243 offset:2048
    v_mfma_f32_16x16x32_bf16 v[148:151], a[168:171], v[196:199], v[148:151]
    v_exp_f32 v181, v181
    v_mfma_f32_16x16x32_bf16 v[152:155], a[172:175], v[196:199], v[152:155]
    v_cvt_pk_bf16_f32 v194, v180, v181
    s_add_u32 m0, s44, 0
    v_mfma_f32_16x16x32_bf16 v[156:159], a[176:179], v[196:199], v[156:159]
    v_exp_f32 v182, v182
    v_mfma_f32_16x16x32_bf16 a[48:51], a[180:183], v[196:199], a[48:51]
    buffer_load_dwordx4 v3, s[52:55], s43 offen offset:0 lds
    v_mfma_f32_16x16x32_bf16 a[52:55], a[184:187], v[196:199], a[52:55]
    v_exp_f32 v183, v183
    v_mfma_f32_16x16x32_bf16 a[56:59], a[188:191], v[196:199], a[56:59]
    v_cvt_pk_bf16_f32 v195, v182, v183
    v_mfma_f32_16x16x32_bf16 a[60:63], a[192:195], v[196:199], a[60:63]
    buffer_load_dwordx4 v4, s[52:55], s43 offen offset:1024 lds
    v_mfma_f32_16x16x32_bf16 v[176:179], a[132:135], v[32:35], v[204:207]
    v_exp_f32 v184, v184
    s_waitcnt vmcnt(14)
    v_mfma_f32_16x16x32_bf16 v[176:179], a[136:139], v[36:39], v[176:179]
    ds_read_b64_tr_b16 a[116:117], v10 offset:16384
    ds_read_b64_tr_b16 a[118:119], v10 offset:18432
    v_mfma_f32_16x16x32_bf16 v[176:179], a[140:143], v[40:43], v[176:179]
    v_exp_f32 v185, v185
    v_mfma_f32_16x16x32_bf16 v[176:179], a[144:147], v[44:47], v[176:179]
    v_cvt_pk_bf16_f32 v196, v184, v185
    ds_read_b64_tr_b16 a[120:121], v11 offset:16384
    v_mfma_f32_16x16x32_bf16 v[180:183], a[148:151], v[32:35], v[204:207]
    v_exp_f32 v186, v186
    v_mfma_f32_16x16x32_bf16 v[180:183], a[152:155], v[36:39], v[180:183]
    ds_read_b64_tr_b16 a[122:123], v11 offset:18432
    ds_read_b64_tr_b16 a[124:125], v12 offset:16384
    v_mfma_f32_16x16x32_bf16 v[180:183], a[156:159], v[40:43], v[180:183]
    v_exp_f32 v187, v187
    v_mfma_f32_16x16x32_bf16 v[180:183], a[160:163], v[44:47], v[180:183]
    v_cvt_pk_bf16_f32 v197, v186, v187
    ds_read_b64_tr_b16 a[126:127], v12 offset:18432
    v_mfma_f32_16x16x32_bf16 a[96:99], v[220:223], v[192:195], a[96:99]
    v_exp_f32 v188, v188
    v_mfma_f32_16x16x32_bf16 v[160:163], a[164:167], v[192:195], v[160:163]
    ds_read_b64_tr_b16 a[128:129], v13 offset:16384
    ds_read_b64_tr_b16 a[130:131], v13 offset:18432
    v_mfma_f32_16x16x32_bf16 v[164:167], a[168:171], v[192:195], v[164:167]
    v_exp_f32 v189, v189
    v_mfma_f32_16x16x32_bf16 v[168:171], a[172:175], v[192:195], v[168:171]
    v_cvt_pk_bf16_f32 v198, v188, v189
    buffer_load_dwordx4 v5, s[52:55], s43 offen offset:2048 lds
    v_mfma_f32_16x16x32_bf16 v[172:175], a[176:179], v[192:195], v[172:175]
    v_exp_f32 v190, v190
    v_mfma_f32_16x16x32_bf16 a[64:67], a[180:183], v[192:195], a[64:67]
    buffer_load_dwordx4 v6, s[52:55], s43 offen offset:3072 lds
    s_add_u32 s43, s43, 36864
    v_mfma_f32_16x16x32_bf16 a[68:71], a[184:187], v[192:195], a[68:71]
    v_exp_f32 v191, v191
    v_mfma_f32_16x16x32_bf16 a[72:75], a[188:191], v[192:195], a[72:75]
    v_cvt_pk_bf16_f32 v199, v190, v191
    s_waitcnt lgkmcnt(8)
    s_add_u32 m0, s44, 65536
    v_mfma_f32_16x16x32_bf16 a[76:79], a[192:195], v[192:195], a[76:79]
    buffer_load_dwordx4 v3, s[52:55], s43 offen offset:0 lds
    v_mfma_f32_16x16x32_bf16 v[184:187], a[132:135], v[48:51], v[208:211]
    v_exp_f32 v176, v176
    s_waitcnt vmcnt(9)
    v_mfma_f32_16x16x32_bf16 v[184:187], a[136:139], v[52:55], v[184:187]
    ds_read_b64_tr_b16 a[164:165], v10 offset:32768
    ds_read_b64_tr_b16 a[166:167], v10 offset:34816
    v_mfma_f32_16x16x32_bf16 v[184:187], a[140:143], v[56:59], v[184:187]
    v_exp_f32 v177, v177
    v_mfma_f32_16x16x32_bf16 v[184:187], a[144:147], v[60:63], v[184:187]
    v_cvt_pk_bf16_f32 v192, v176, v177
    ds_read_b64_tr_b16 a[168:169], v11 offset:32768
    v_mfma_f32_16x16x32_bf16 v[188:191], a[148:151], v[48:51], v[208:211]
    v_exp_f32 v178, v178
    v_mfma_f32_16x16x32_bf16 v[188:191], a[152:155], v[52:55], v[188:191]
    ds_read_b64_tr_b16 a[170:171], v11 offset:34816
    ds_read_b64_tr_b16 a[172:173], v12 offset:32768
    v_mfma_f32_16x16x32_bf16 v[188:191], a[156:159], v[56:59], v[188:191]
    v_exp_f32 v179, v179
    v_mfma_f32_16x16x32_bf16 v[188:191], a[160:163], v[60:63], v[188:191]
    v_cvt_pk_bf16_f32 v193, v178, v179
    ds_read_b64_tr_b16 a[174:175], v12 offset:34816
    v_mfma_f32_16x16x32_bf16 a[80:83], v[220:223], v[196:199], a[80:83]
    v_exp_f32 v180, v180
    v_mfma_f32_16x16x32_bf16 v[96:99], a[196:199], v[196:199], v[96:99]
    ds_read_b64_tr_b16 a[176:177], v13 offset:32768
    ds_read_b64_tr_b16 a[178:179], v13 offset:34816
    v_mfma_f32_16x16x32_bf16 v[100:103], a[200:203], v[196:199], v[100:103]
    v_exp_f32 v181, v181
    v_mfma_f32_16x16x32_bf16 v[104:107], a[204:207], v[196:199], v[104:107]
    v_cvt_pk_bf16_f32 v194, v180, v181
    buffer_load_dwordx4 v4, s[52:55], s43 offen offset:1024 lds
    v_mfma_f32_16x16x32_bf16 v[108:111], a[208:211], v[196:199], v[108:111]
    v_exp_f32 v182, v182
    v_mfma_f32_16x16x32_bf16 a[0:3], a[212:215], v[196:199], a[0:3]
    buffer_load_dwordx4 v5, s[52:55], s43 offen offset:2048 lds
    v_mfma_f32_16x16x32_bf16 a[4:7], a[216:219], v[196:199], a[4:7]
    v_exp_f32 v183, v183
    v_mfma_f32_16x16x32_bf16 a[8:11], a[220:223], v[196:199], a[8:11]
    v_cvt_pk_bf16_f32 v195, v182, v183
    v_mfma_f32_16x16x32_bf16 a[12:15], a[224:227], v[196:199], a[12:15]
    buffer_load_dwordx4 v6, s[52:55], s43 offen offset:3072 lds
    s_add_u32 s43, s43, 36864
    v_mfma_f32_16x16x32_bf16 v[176:179], a[132:135], v[64:67], v[212:215]
    v_exp_f32 v184, v184
    s_waitcnt vmcnt(8)
    v_mfma_f32_16x16x32_bf16 v[176:179], a[136:139], v[68:71], v[176:179]
    ds_read_b64_tr_b16 a[180:181], v14 offset:32768
    ds_read_b64_tr_b16 a[182:183], v14 offset:34816
    v_mfma_f32_16x16x32_bf16 v[176:179], a[140:143], v[72:75], v[176:179]
    v_exp_f32 v185, v185
    v_mfma_f32_16x16x32_bf16 v[176:179], a[144:147], v[76:79], v[176:179]
    v_cvt_pk_bf16_f32 v196, v184, v185
    ds_read_b64_tr_b16 a[184:185], v15 offset:32768
    v_mfma_f32_16x16x32_bf16 v[180:183], a[148:151], v[64:67], v[212:215]
    v_exp_f32 v186, v186
    v_mfma_f32_16x16x32_bf16 v[180:183], a[152:155], v[68:71], v[180:183]
    ds_read_b64_tr_b16 a[186:187], v15 offset:34816
    ds_read_b64_tr_b16 a[188:189], v242 offset:32768
    v_mfma_f32_16x16x32_bf16 v[180:183], a[156:159], v[72:75], v[180:183]
    v_exp_f32 v187, v187
    v_mfma_f32_16x16x32_bf16 v[180:183], a[160:163], v[76:79], v[180:183]
    v_cvt_pk_bf16_f32 v197, v186, v187
    ds_read_b64_tr_b16 a[190:191], v242 offset:34816
    v_mfma_f32_16x16x32_bf16 a[84:87], v[220:223], v[192:195], a[84:87]
    v_exp_f32 v188, v188
    v_mfma_f32_16x16x32_bf16 v[112:115], a[196:199], v[192:195], v[112:115]
    ds_read_b64_tr_b16 a[192:193], v243 offset:32768
    ds_read_b64_tr_b16 a[194:195], v243 offset:34816
    v_mfma_f32_16x16x32_bf16 v[116:119], a[200:203], v[192:195], v[116:119]
    v_exp_f32 v189, v189
    v_mfma_f32_16x16x32_bf16 v[120:123], a[204:207], v[192:195], v[120:123]
    v_cvt_pk_bf16_f32 v198, v188, v189
    ds_write_b128 v7, a[0:3] offset:0
    v_mfma_f32_16x16x32_bf16 v[124:127], a[208:211], v[192:195], v[124:127]
    v_exp_f32 v190, v190
    v_mfma_f32_16x16x32_bf16 a[16:19], a[212:215], v[192:195], a[16:19]
    ds_write_b128 v7, a[4:7] offset:1024
    v_mfma_f32_16x16x32_bf16 a[20:23], a[216:219], v[192:195], a[20:23]
    v_exp_f32 v191, v191
    v_mfma_f32_16x16x32_bf16 a[24:27], a[220:223], v[192:195], a[24:27]
    v_cvt_pk_bf16_f32 v199, v190, v191
    ds_write_b128 v7, a[8:11] offset:2048
    v_mfma_f32_16x16x32_bf16 a[28:31], a[224:227], v[192:195], a[28:31]
    ds_write_b128 v7, a[12:15] offset:3072
    s_waitcnt lgkmcnt(14)
    s_add_u32 m0, s44, 16384
    v_mfma_f32_16x16x32_bf16 v[184:187], a[132:135], v[80:83], v[216:219]
    v_exp_f32 v176, v176
    v_mfma_f32_16x16x32_bf16 v[184:187], a[136:139], v[84:87], v[184:187]
    ds_write_b128 v7, a[16:19] offset:4096
    v_mfma_f32_16x16x32_bf16 v[184:187], a[140:143], v[88:91], v[184:187]
    v_exp_f32 v177, v177
    v_mfma_f32_16x16x32_bf16 v[184:187], a[144:147], v[92:95], v[184:187]
    v_cvt_pk_bf16_f32 v192, v176, v177
    buffer_load_dwordx4 v3, s[52:55], s43 offen offset:0 lds
    v_mfma_f32_16x16x32_bf16 v[188:191], a[148:151], v[80:83], v[216:219]
    v_exp_f32 v178, v178
    v_mfma_f32_16x16x32_bf16 v[188:191], a[152:155], v[84:87], v[188:191]
    ds_write_b128 v7, a[20:23] offset:5120
    v_mfma_f32_16x16x32_bf16 v[188:191], a[156:159], v[88:91], v[188:191]
    v_exp_f32 v179, v179
    v_mfma_f32_16x16x32_bf16 v[188:191], a[160:163], v[92:95], v[188:191]
    v_cvt_pk_bf16_f32 v193, v178, v179
    buffer_load_dwordx4 v4, s[52:55], s43 offen offset:1024 lds
    v_mfma_f32_16x16x32_bf16 a[88:91], v[220:223], v[196:199], a[88:91]
    v_exp_f32 v180, v180
    v_mfma_f32_16x16x32_bf16 v[128:131], a[196:199], v[196:199], v[128:131]
    ds_write_b128 v7, a[24:27] offset:6144
    v_mfma_f32_16x16x32_bf16 v[132:135], a[200:203], v[196:199], v[132:135]
    v_exp_f32 v181, v181
    v_mfma_f32_16x16x32_bf16 v[136:139], a[204:207], v[196:199], v[136:139]
    v_cvt_pk_bf16_f32 v194, v180, v181
    buffer_load_dwordx4 v5, s[52:55], s43 offen offset:2048 lds
    v_mfma_f32_16x16x32_bf16 v[140:143], a[208:211], v[196:199], v[140:143]
    v_exp_f32 v182, v182
    v_mfma_f32_16x16x32_bf16 a[32:35], a[212:215], v[196:199], a[32:35]
    ds_write_b128 v7, a[28:31] offset:7168
    v_mfma_f32_16x16x32_bf16 a[36:39], a[216:219], v[196:199], a[36:39]
    v_exp_f32 v183, v183
    v_mfma_f32_16x16x32_bf16 a[40:43], a[220:223], v[196:199], a[40:43]
    v_cvt_pk_bf16_f32 v195, v182, v183
    buffer_load_dwordx4 v6, s[52:55], s43 offen offset:3072 lds
    s_add_u32 s43, s43, 36864
    v_mfma_f32_16x16x32_bf16 a[44:47], a[224:227], v[196:199], a[44:47]
    s_waitcnt lgkmcnt(8)
    s_barrier
    v_mfma_f32_16x16x32_bf16 a[92:95], v[220:223], v[192:195], a[92:95]
    v_exp_f32 v184, v184
    ds_read_b64_tr_b16 a[132:133], v14 offset:16384
    v_mfma_f32_16x16x32_bf16 v[144:147], a[196:199], v[192:195], v[144:147]
    v_exp_f32 v185, v185
    ds_read_b64_tr_b16 a[134:135], v14 offset:18432
    ds_write_b128 v7, a[32:35] offset:8192
    v_mfma_f32_16x16x32_bf16 v[148:151], a[200:203], v[192:195], v[148:151]
    v_exp_f32 v186, v186
    ds_read_b64_tr_b16 a[136:137], v15 offset:16384
    v_mfma_f32_16x16x32_bf16 v[152:155], a[204:207], v[192:195], v[152:155]
    v_exp_f32 v187, v187
    ds_read_b64_tr_b16 a[138:139], v15 offset:18432
    ds_write_b128 v7, a[36:39] offset:9216
    v_mfma_f32_16x16x32_bf16 v[156:159], a[208:211], v[192:195], v[156:159]
    v_exp_f32 v188, v188
    ds_read_b64_tr_b16 a[140:141], v242 offset:16384
    v_mfma_f32_16x16x32_bf16 a[48:51], a[212:215], v[192:195], a[48:51]
    v_exp_f32 v189, v189
    ds_read_b64_tr_b16 a[142:143], v242 offset:18432
    ds_write_b128 v7, a[40:43] offset:10240
    v_mfma_f32_16x16x32_bf16 a[52:55], a[216:219], v[192:195], a[52:55]
    v_exp_f32 v190, v190
    ds_read_b64_tr_b16 a[144:145], v243 offset:16384
    v_mfma_f32_16x16x32_bf16 a[56:59], a[220:223], v[192:195], a[56:59]
    v_exp_f32 v191, v191
    ds_read_b64_tr_b16 a[146:147], v243 offset:18432
    ds_write_b128 v7, a[44:47] offset:11264
    v_mfma_f32_16x16x32_bf16 a[60:63], a[224:227], v[192:195], a[60:63]
    v_cvt_pk_bf16_f32 v196, v184, v185
    v_cvt_pk_bf16_f32 v197, v186, v187
    v_cvt_pk_bf16_f32 v198, v188, v189
    v_cvt_pk_bf16_f32 v199, v190, v191
    v_accvgpr_read_b32 v244, a80
    v_accvgpr_read_b32 v245, a84
    v_accvgpr_read_b32 v246, a88
    v_accvgpr_read_b32 v247, a92
    v_mfma_f32_16x16x32_bf16 a[96:99], v[220:223], v[196:199], a[96:99]
    ds_write_b128 v8, a[48:51] offset:0
    s_waitcnt vmcnt(8)
    ds_read_b64_tr_b16 a[148:149], v10 offset:0
    ds_read_b64_tr_b16 a[150:151], v10 offset:2048
    v_mov_b32 v249, 0x33800000
    v_mov_b32 v250, 0x4e800000
    s_mov_b64 s[36:37], 0
    v_mfma_f32_16x16x32_bf16 a[64:67], a[212:215], v[196:199], a[64:67]
    ds_write_b128 v8, a[52:55] offset:1024
    ds_read_b64_tr_b16 a[152:153], v11 offset:0
    ds_read_b64_tr_b16 a[154:155], v11 offset:2048
    v_cmp_nge_f32 vcc, v244, v249
    s_or_b64 s[36:37], s[36:37], vcc
    v_cmp_nle_f32 vcc, v244, v250
    s_or_b64 s[36:37], s[36:37], vcc
    v_mfma_f32_16x16x32_bf16 a[68:71], a[216:219], v[196:199], a[68:71]
    ds_write_b128 v8, a[56:59] offset:2048
    ds_read_b64_tr_b16 a[156:157], v12 offset:0
    ds_read_b64_tr_b16 a[158:159], v12 offset:2048
    v_cmp_nge_f32 vcc, v245, v249
    s_or_b64 s[36:37], s[36:37], vcc
    v_cmp_nle_f32 vcc, v245, v250
    s_or_b64 s[36:37], s[36:37], vcc
    v_mfma_f32_16x16x32_bf16 a[72:75], a[220:223], v[196:199], a[72:75]
    ds_write_b128 v8, a[60:63] offset:3072
    ds_read_b64_tr_b16 a[160:161], v13 offset:0
    ds_read_b64_tr_b16 a[162:163], v13 offset:2048
    v_cmp_nge_f32 vcc, v246, v249
    s_or_b64 s[36:37], s[36:37], vcc
    v_cmp_nle_f32 vcc, v246, v250
    s_or_b64 s[36:37], s[36:37], vcc
    v_mfma_f32_16x16x32_bf16 a[76:79], a[224:227], v[196:199], a[76:79]
    v_cmp_nge_f32 vcc, v247, v249
    s_or_b64 s[36:37], s[36:37], vcc
    v_cmp_nle_f32 vcc, v247, v250
    s_or_b64 s[36:37], s[36:37], vcc
    s_waitcnt lgkmcnt(13)
    s_add_u32 m0, s44, 81920
    v_mfma_f32_16x16x32_bf16 v[160:163], a[196:199], v[196:199], v[160:163]
    v_accvgpr_read_b32 v248, a96
    buffer_load_dwordx4 v3, s[52:55], s43 offen offset:0 lds
    v_mfma_f32_16x16x32_bf16 v[164:167], a[200:203], v[196:199], v[164:167]
    ds_write_b128 v8, a[64:67] offset:4096
    buffer_load_dwordx4 v4, s[52:55], s43 offen offset:1024 lds
    v_mfma_f32_16x16x32_bf16 v[168:171], a[204:207], v[196:199], v[168:171]
    ds_write_b128 v8, a[68:71] offset:5120
    buffer_load_dwordx4 v5, s[52:55], s43 offen offset:2048 lds
    v_cmp_nge_f32 vcc, v248, v249
    s_or_b64 s[36:37], s[36:37], vcc
    v_cmp_nle_f32 vcc, v248, v250
    s_or_b64 s[36:37], s[36:37], vcc
    v_mfma_f32_16x16x32_bf16 v[172:175], a[208:211], v[196:199], v[172:175]
    ds_write_b128 v8, a[72:75] offset:6144
    buffer_load_dwordx4 v6, s[52:55], s43 offen offset:3072 lds
    s_add_u32 s43, s43, 36864
    s_cmp_lg_u64 s[36:37], 0
    s_cselect_b32 s38, 1, 0
    v_mov_b32 v249, s38
    s_lshl_b32 s34, s3, 2
    s_add_u32 s34, s34, 155648
    v_mov_b32 v250, s34
    ds_write_b128 v8, a[76:79] offset:7168
    ds_write_b32 v250, v249
    s_mul_i32 s34, s3, 1280
    s_add_u32 s34, s34, 155904
    v_lshlrev_b32 v251, 2, v2
    v_add_u32 v250, s34, v251
    ds_write_b32 v250, v244 offset:0
    ds_write_b32 v250, v245 offset:256
    ds_write_b32 v250, v246 offset:512
    ds_write_b32 v250, v247 offset:768
    ds_write_b32 v250, v248 offset:1024
    s_waitcnt vmcnt(8)
    ds_read_b64_tr_b16 a[212:213], v14 offset:0
    ds_read_b64_tr_b16 a[214:215], v14 offset:2048
    ds_read_b64_tr_b16 a[216:217], v15 offset:0
    ds_read_b64_tr_b16 a[218:219], v15 offset:2048
    ds_read_b64_tr_b16 a[220:221], v242 offset:0
    ds_read_b64_tr_b16 a[222:223], v242 offset:2048
    ds_read_b64_tr_b16 a[224:225], v243 offset:0
    ds_read_b64_tr_b16 a[226:227], v243 offset:2048
    s_waitcnt lgkmcnt(14)
    s_add_u32 m0, s44, 0
    s_nop 0
    buffer_load_dwordx4 v3, s[52:55], s43 offen offset:0 lds
    buffer_load_dwordx4 v4, s[52:55], s43 offen offset:1024 lds
    buffer_load_dwordx4 v5, s[52:55], s43 offen offset:2048 lds
    buffer_load_dwordx4 v6, s[52:55], s43 offen offset:3072 lds
    s_add_u32 s43, s43, 36864
    s_xor_b32 s35, s3, 2
    s_mul_i32 s34, s35, 1280
    s_add_u32 s34, s34, 155904
    v_add_u32 v254, s34, v251
    v_mov_b32 v251, 155648
    s_mov_b32 s45, 131072
    s_cmp_eq_u32 s3, 1
    s_cselect_b32 s45, 143360, s45
    s_cmp_eq_u32 s3, 2
    s_cselect_b32 s45, 49152, s45
    s_cmp_eq_u32 s3, 3
    s_cselect_b32 s45, 114688, s45
    s_mov_b32 s46, 98304
    s_cmp_eq_u32 s3, 1
    s_cselect_b32 s46, 106496, s46
    s_cmp_eq_u32 s3, 2
    s_cselect_b32 s46, 32768, s46
    s_cmp_eq_u32 s3, 3
    s_cselect_b32 s46, 40960, s46
    v_add_u32 v252, s45, v9
    v_add_u32 v253, s46, v9
    s_mul_i32 s34, s7, 10
    s_mul_i32 s35, s4, 5
    s_add_u32 s34, s34, s35
    s_lshl_b32 s34, s34, 7
    s_lshl_b32 s35, s6, 2
    s_add_u32 s34, s34, s35
    s_lshl_b32 s35, s5, 1
    s_add_u32 s34, s34, s35
    s_lshl_b32 s42, s34, 10
    s_waitcnt lgkmcnt(0)
    s_barrier
    ds_read_b128 v[192:195], v251
    ds_read_b32 v184, v254 offset:0
    ds_read_b32 v185, v254 offset:256
    ds_read_b32 v186, v254 offset:512
    ds_read_b32 v187, v254 offset:768
    ds_read_b32 v188, v254 offset:1024
    ds_read_b128 v[200:203], v252 offset:0
    ds_read_b128 v[204:207], v252 offset:1024
    ds_read_b128 v[208:211], v252 offset:2048
    ds_read_b128 v[212:215], v252 offset:3072
    s_add_u32 m0, s44, 65536
    s_nop 0
    buffer_load_dwordx4 v3, s[52:55], s43 offen offset:0 lds
    buffer_load_dwordx4 v4, s[52:55], s43 offen offset:1024 lds
    buffer_load_dwordx4 v5, s[52:55], s43 offen offset:2048 lds
    buffer_load_dwordx4 v6, s[52:55], s43 offen offset:3072 lds
    s_add_u32 s43, s43, 36864
    s_waitcnt lgkmcnt(4)
    v_or_b32 v192, v192, v193
    v_or3_b32 v192, v192, v194, v195
    s_nop 0
    v_readfirstlane_b32 s38, v192
    s_xor_b32 s39, s33, 1
    s_and_b32 s38, s38, s39
    s_cmp_lg_u32 s38, 0
    s_cbranch_scc1 L_fallback
    s_waitcnt vmcnt(12)
    ds_read_b64_tr_b16 a[196:197], v10 offset:16384
    ds_read_b64_tr_b16 a[198:199], v10 offset:18432
    ds_read_b64_tr_b16 a[200:201], v11 offset:16384
    ds_read_b64_tr_b16 a[202:203], v11 offset:18432
    ds_read_b64_tr_b16 a[204:205], v12 offset:16384
    ds_read_b64_tr_b16 a[206:207], v12 offset:18432
    ds_read_b64_tr_b16 a[208:209], v13 offset:16384
    ds_read_b64_tr_b16 a[210:211], v13 offset:18432
    ds_read_b128 v[32:35], v252 offset:4096
    ds_read_b128 v[36:39], v252 offset:5120
    ds_read_b128 v[40:43], v252 offset:6144
    ds_read_b128 v[44:47], v252 offset:7168
    ds_read_b128 v[48:51], v252 offset:8192
    ds_read_b128 v[52:55], v252 offset:9216
    ds_read_b128 v[56:59], v252 offset:10240
    ds_read_b128 v[60:63], v252 offset:11264
    ds_read_b128 v[64:67], v253 offset:0
    ds_read_b128 v[68:71], v253 offset:1024
    ds_read_b128 v[72:75], v253 offset:2048
    ds_read_b128 v[76:79], v253 offset:3072
    ds_read_b128 v[80:83], v253 offset:4096
    ds_read_b128 v[84:87], v253 offset:5120
    ds_read_b128 v[88:91], v253 offset:6144
    ds_read_b128 v[92:95], v253 offset:7168
    v_add_f32 v244, v244, v184
    v_add_f32 v245, v245, v185
    v_add_f32 v246, v246, v186
    v_add_f32 v247, v247, v187
    v_add_f32 v248, v248, v188
    v_rcp_f32 v244, v244
    v_rcp_f32 v245, v245
    v_rcp_f32 v246, v246
    v_rcp_f32 v247, v247
    v_rcp_f32 v248, v248
    s_waitcnt lgkmcnt(14)
    s_add_u32 m0, s44, 16384
    s_nop 0
    buffer_load_dwordx4 v3, s[52:55], s43 offen offset:0 lds
    buffer_load_dwordx4 v4, s[52:55], s43 offen offset:1024 lds
    buffer_load_dwordx4 v5, s[52:55], s43 offen offset:2048 lds
    buffer_load_dwordx4 v6, s[52:55], s43 offen offset:3072 lds
    s_add_u32 s43, s43, 36864
    s_waitcnt vmcnt(12)
    ds_read_b64_tr_b16 a[0:1], v14 offset:16384
    ds_read_b64_tr_b16 a[2:3], v14 offset:18432
    ds_read_b64_tr_b16 a[4:5], v15 offset:16384
    ds_read_b64_tr_b16 a[6:7], v15 offset:18432
    ds_read_b64_tr_b16 a[8:9], v242 offset:16384
    ds_read_b64_tr_b16 a[10:11], v242 offset:18432
    ds_read_b64_tr_b16 a[12:13], v243 offset:16384
    ds_read_b64_tr_b16 a[14:15], v243 offset:18432
    v_pk_add_f32 v[96:97], v[96:97], v[200:201]
    v_pk_add_f32 v[98:99], v[98:99], v[202:203]
    v_pk_add_f32 v[100:101], v[100:101], v[204:205]
    v_pk_add_f32 v[102:103], v[102:103], v[206:207]
    v_pk_add_f32 v[104:105], v[104:105], v[208:209]
    v_pk_add_f32 v[106:107], v[106:107], v[210:211]
    v_pk_add_f32 v[108:109], v[108:109], v[212:213]
    v_pk_add_f32 v[110:111], v[110:111], v[214:215]
    v_pk_mul_f32 v[96:97], v[96:97], v[244:245] op_sel_hi:[1,0]
    v_pk_mul_f32 v[98:99], v[98:99], v[244:245] op_sel_hi:[1,0]
    v_pk_mul_f32 v[100:101], v[100:101], v[244:245] op_sel_hi:[1,0]
    v_pk_mul_f32 v[102:103], v[102:103], v[244:245] op_sel_hi:[1,0]
    v_pk_mul_f32 v[104:105], v[104:105], v[244:245] op_sel_hi:[1,0]
    v_pk_mul_f32 v[106:107], v[106:107], v[244:245] op_sel_hi:[1,0]
    v_pk_mul_f32 v[108:109], v[108:109], v[244:245] op_sel_hi:[1,0]
    v_pk_mul_f32 v[110:111], v[110:111], v[244:245] op_sel_hi:[1,0]
    v_cvt_pk_bf16_f32 v16, v96, v97
    v_cvt_pk_bf16_f32 v17, v98, v99
    v_cvt_pk_bf16_f32 v18, v100, v101
    v_cvt_pk_bf16_f32 v19, v102, v103
    v_cvt_pk_bf16_f32 v20, v104, v105
    v_cvt_pk_bf16_f32 v21, v106, v107
    v_cvt_pk_bf16_f32 v22, v108, v109
    v_cvt_pk_bf16_f32 v23, v110, v111
    buffer_store_dwordx4 v[16:19], v9, s[24:27], s42 offen offset:0 sc1
    buffer_store_dwordx4 v[20:23], v9, s[24:27], s42 offen offset:1024 sc1
    s_add_u32 s42, s42, 131072
    s_waitcnt lgkmcnt(14)
    v_pk_add_f32 v[112:113], v[112:113], v[32:33]
    v_pk_add_f32 v[114:115], v[114:115], v[34:35]
    v_pk_add_f32 v[116:117], v[116:117], v[36:37]
    v_pk_add_f32 v[118:119], v[118:119], v[38:39]
    v_pk_add_f32 v[120:121], v[120:121], v[40:41]
    v_pk_add_f32 v[122:123], v[122:123], v[42:43]
    v_pk_add_f32 v[124:125], v[124:125], v[44:45]
    v_pk_add_f32 v[126:127], v[126:127], v[46:47]
    v_pk_mul_f32 v[112:113], v[112:113], v[244:245] op_sel:[0,1] op_sel_hi:[1,1]
    v_pk_mul_f32 v[114:115], v[114:115], v[244:245] op_sel:[0,1] op_sel_hi:[1,1]
    v_pk_mul_f32 v[116:117], v[116:117], v[244:245] op_sel:[0,1] op_sel_hi:[1,1]
    v_pk_mul_f32 v[118:119], v[118:119], v[244:245] op_sel:[0,1] op_sel_hi:[1,1]
    v_pk_mul_f32 v[120:121], v[120:121], v[244:245] op_sel:[0,1] op_sel_hi:[1,1]
    v_pk_mul_f32 v[122:123], v[122:123], v[244:245] op_sel:[0,1] op_sel_hi:[1,1]
    v_pk_mul_f32 v[124:125], v[124:125], v[244:245] op_sel:[0,1] op_sel_hi:[1,1]
    v_pk_mul_f32 v[126:127], v[126:127], v[244:245] op_sel:[0,1] op_sel_hi:[1,1]
    v_cvt_pk_bf16_f32 v32, v112, v113
    v_cvt_pk_bf16_f32 v33, v114, v115
    v_cvt_pk_bf16_f32 v34, v116, v117
    v_cvt_pk_bf16_f32 v35, v118, v119
    v_cvt_pk_bf16_f32 v36, v120, v121
    v_cvt_pk_bf16_f32 v37, v122, v123
    v_cvt_pk_bf16_f32 v38, v124, v125
    v_cvt_pk_bf16_f32 v39, v126, v127
    buffer_store_dwordx4 v[32:35], v9, s[24:27], s42 offen offset:0 sc1
    buffer_store_dwordx4 v[36:39], v9, s[24:27], s42 offen offset:1024 sc1
    s_add_u32 s42, s42, 131072
    s_waitcnt lgkmcnt(0)
    s_barrier
    s_waitcnt vmcnt(12)
    ds_read_b64_tr_b16 a[16:17], v10 offset:0
    ds_read_b64_tr_b16 a[18:19], v10 offset:2048
    ds_read_b64_tr_b16 a[20:21], v11 offset:0
    ds_read_b64_tr_b16 a[22:23], v11 offset:2048
    ds_read_b64_tr_b16 a[24:25], v12 offset:0
    ds_read_b64_tr_b16 a[26:27], v12 offset:2048
    ds_read_b64_tr_b16 a[28:29], v13 offset:0
    ds_read_b64_tr_b16 a[30:31], v13 offset:2048
    v_pk_add_f32 v[128:129], v[128:129], v[48:49]
    v_pk_add_f32 v[130:131], v[130:131], v[50:51]
    v_pk_add_f32 v[132:133], v[132:133], v[52:53]
    v_pk_add_f32 v[134:135], v[134:135], v[54:55]
    v_pk_add_f32 v[136:137], v[136:137], v[56:57]
    v_pk_add_f32 v[138:139], v[138:139], v[58:59]
    v_pk_add_f32 v[140:141], v[140:141], v[60:61]
    v_pk_add_f32 v[142:143], v[142:143], v[62:63]
    v_pk_mul_f32 v[128:129], v[128:129], v[246:247] op_sel_hi:[1,0]
    v_pk_mul_f32 v[130:131], v[130:131], v[246:247] op_sel_hi:[1,0]
    v_pk_mul_f32 v[132:133], v[132:133], v[246:247] op_sel_hi:[1,0]
    v_pk_mul_f32 v[134:135], v[134:135], v[246:247] op_sel_hi:[1,0]
    v_pk_mul_f32 v[136:137], v[136:137], v[246:247] op_sel_hi:[1,0]
    v_pk_mul_f32 v[138:139], v[138:139], v[246:247] op_sel_hi:[1,0]
    v_pk_mul_f32 v[140:141], v[140:141], v[246:247] op_sel_hi:[1,0]
    v_pk_mul_f32 v[142:143], v[142:143], v[246:247] op_sel_hi:[1,0]
    v_cvt_pk_bf16_f32 v48, v128, v129
    v_cvt_pk_bf16_f32 v49, v130, v131
    v_cvt_pk_bf16_f32 v50, v132, v133
    v_cvt_pk_bf16_f32 v51, v134, v135
    v_cvt_pk_bf16_f32 v52, v136, v137
    v_cvt_pk_bf16_f32 v53, v138, v139
    v_cvt_pk_bf16_f32 v54, v140, v141
    v_cvt_pk_bf16_f32 v55, v142, v143
    buffer_store_dwordx4 v[48:51], v9, s[24:27], s42 offen offset:0 sc1
    buffer_store_dwordx4 v[52:55], v9, s[24:27], s42 offen offset:1024 sc1
    s_add_u32 s42, s42, 131072
    s_waitcnt vmcnt(10)
    ds_read_b64_tr_b16 a[32:33], v14 offset:0
    ds_read_b64_tr_b16 a[34:35], v14 offset:2048
    ds_read_b64_tr_b16 a[36:37], v15 offset:0
    ds_read_b64_tr_b16 a[38:39], v15 offset:2048
    ds_read_b64_tr_b16 a[40:41], v242 offset:0
    ds_read_b64_tr_b16 a[42:43], v242 offset:2048
    ds_read_b64_tr_b16 a[44:45], v243 offset:0
    ds_read_b64_tr_b16 a[46:47], v243 offset:2048
    v_pk_add_f32 v[144:145], v[144:145], v[64:65]
    v_pk_add_f32 v[146:147], v[146:147], v[66:67]
    v_pk_add_f32 v[148:149], v[148:149], v[68:69]
    v_pk_add_f32 v[150:151], v[150:151], v[70:71]
    v_pk_add_f32 v[152:153], v[152:153], v[72:73]
    v_pk_add_f32 v[154:155], v[154:155], v[74:75]
    v_pk_add_f32 v[156:157], v[156:157], v[76:77]
    v_pk_add_f32 v[158:159], v[158:159], v[78:79]
    v_pk_mul_f32 v[144:145], v[144:145], v[246:247] op_sel:[0,1] op_sel_hi:[1,1]
    v_pk_mul_f32 v[146:147], v[146:147], v[246:247] op_sel:[0,1] op_sel_hi:[1,1]
    v_pk_mul_f32 v[148:149], v[148:149], v[246:247] op_sel:[0,1] op_sel_hi:[1,1]
    v_pk_mul_f32 v[150:151], v[150:151], v[246:247] op_sel:[0,1] op_sel_hi:[1,1]
    v_pk_mul_f32 v[152:153], v[152:153], v[246:247] op_sel:[0,1] op_sel_hi:[1,1]
    v_pk_mul_f32 v[154:155], v[154:155], v[246:247] op_sel:[0,1] op_sel_hi:[1,1]
    v_pk_mul_f32 v[156:157], v[156:157], v[246:247] op_sel:[0,1] op_sel_hi:[1,1]
    v_pk_mul_f32 v[158:159], v[158:159], v[246:247] op_sel:[0,1] op_sel_hi:[1,1]
    v_cvt_pk_bf16_f32 v64, v144, v145
    v_cvt_pk_bf16_f32 v65, v146, v147
    v_cvt_pk_bf16_f32 v66, v148, v149
    v_cvt_pk_bf16_f32 v67, v150, v151
    v_cvt_pk_bf16_f32 v68, v152, v153
    v_cvt_pk_bf16_f32 v69, v154, v155
    v_cvt_pk_bf16_f32 v70, v156, v157
    v_cvt_pk_bf16_f32 v71, v158, v159
    buffer_store_dwordx4 v[64:67], v9, s[24:27], s42 offen offset:0 sc1
    buffer_store_dwordx4 v[68:71], v9, s[24:27], s42 offen offset:1024 sc1
    s_add_u32 s42, s42, 131072
    s_waitcnt vmcnt(8)
    ds_read_b64_tr_b16 a[48:49], v10 offset:16384
    ds_read_b64_tr_b16 a[50:51], v10 offset:18432
    ds_read_b64_tr_b16 a[52:53], v11 offset:16384
    ds_read_b64_tr_b16 a[54:55], v11 offset:18432
    ds_read_b64_tr_b16 a[56:57], v12 offset:16384
    ds_read_b64_tr_b16 a[58:59], v12 offset:18432
    ds_read_b64_tr_b16 a[60:61], v13 offset:16384
    ds_read_b64_tr_b16 a[62:63], v13 offset:18432
    v_pk_add_f32 v[160:161], v[160:161], v[80:81]
    v_pk_add_f32 v[162:163], v[162:163], v[82:83]
    v_pk_add_f32 v[164:165], v[164:165], v[84:85]
    v_pk_add_f32 v[166:167], v[166:167], v[86:87]
    v_pk_add_f32 v[168:169], v[168:169], v[88:89]
    v_pk_add_f32 v[170:171], v[170:171], v[90:91]
    v_pk_add_f32 v[172:173], v[172:173], v[92:93]
    v_pk_add_f32 v[174:175], v[174:175], v[94:95]
    v_pk_mul_f32 v[160:161], v[160:161], v[248:249] op_sel_hi:[1,0]
    v_pk_mul_f32 v[162:163], v[162:163], v[248:249] op_sel_hi:[1,0]
    v_pk_mul_f32 v[164:165], v[164:165], v[248:249] op_sel_hi:[1,0]
    v_pk_mul_f32 v[166:167], v[166:167], v[248:249] op_sel_hi:[1,0]
    v_pk_mul_f32 v[168:169], v[168:169], v[248:249] op_sel_hi:[1,0]
    v_pk_mul_f32 v[170:171], v[170:171], v[248:249] op_sel_hi:[1,0]
    v_pk_mul_f32 v[172:173], v[172:173], v[248:249] op_sel_hi:[1,0]
    v_pk_mul_f32 v[174:175], v[174:175], v[248:249] op_sel_hi:[1,0]
    v_cvt_pk_bf16_f32 v80, v160, v161
    v_cvt_pk_bf16_f32 v81, v162, v163
    v_cvt_pk_bf16_f32 v82, v164, v165
    v_cvt_pk_bf16_f32 v83, v166, v167
    v_cvt_pk_bf16_f32 v84, v168, v169
    v_cvt_pk_bf16_f32 v85, v170, v171
    v_cvt_pk_bf16_f32 v86, v172, v173
    v_cvt_pk_bf16_f32 v87, v174, v175
    buffer_store_dwordx4 v[80:83], v9, s[24:27], s42 offen offset:0 sc1
    buffer_store_dwordx4 v[84:87], v9, s[24:27], s42 offen offset:1024 sc1
    v_mov_b32 v16, v10
    v_mov_b32 v20, v14
    v_add_u32 v24, 65536, v14
    v_mov_b32 v17, v11
    v_mov_b32 v21, v15
    v_add_u32 v25, 65536, v15
    v_mov_b32 v18, v12
    v_mov_b32 v22, v242
    v_add_u32 v26, 65536, v242
    v_mov_b32 v19, v13
    v_mov_b32 v23, v243
    v_add_u32 v27, 65536, v243
    s_mul_i32 s34, s40, 393216
    s_lshl_b32 s35, s3, 15
    s_add_u32 s42, s34, s35
    v_add_u32 v8, 131072, v9
    v_mov_b32 v7, v9
    v_add_u32 v9, 262144, v9
    s_mul_i32 s34, s40, 48
    s_mul_i32 s35, s34, 52429
    s_lshr_b32 s35, s35, 23
    s_add_u32 s34, s34, 47
    s_min_u32 s34, s34, 1279
    s_mul_i32 s36, s34, 52429
    s_lshr_b32 s36, s36, 23
    s_lshl_b32 s35, s35, 5
    s_lshl_b32 s36, s36, 5
    v_mov_b32 v10, s35
    v_mov_b32 v11, s36
    v_cmp_eq_u32 vcc, 1, v2
    s_nop 1
    v_cndmask_b32 v1, v10, v11, vcc
    s_cmp_ge_u32 s2, 243
    s_cbranch_scc1 L_t_tailwg
    s_waitcnt lgkmcnt(0)
    s_add_u32 m0, s44, 81920
    s_nop 0
    buffer_load_dwordx4 v3, s[52:55], s43 offen offset:0 lds
    buffer_load_dwordx4 v4, s[52:55], s43 offen offset:1024 lds
    buffer_load_dwordx4 v5, s[52:55], s43 offen offset:2048 lds
    buffer_load_dwordx4 v6, s[52:55], s43 offen offset:3072 lds
    s_add_u32 s43, s43, 36864
    s_add_u32 m0, s44, 0
    s_nop 0
    buffer_load_dwordx4 v3, s[52:55], s43 offen offset:0 lds
    buffer_load_dwordx4 v4, s[52:55], s43 offen offset:1024 lds
    buffer_load_dwordx4 v5, s[52:55], s43 offen offset:2048 lds
    buffer_load_dwordx4 v6, s[52:55], s43 offen offset:3072 lds
    s_add_u32 s43, s43, 36864
    s_add_u32 m0, s44, 65536
    s_nop 0
    buffer_load_dwordx4 v3, s[52:55], s43 offen offset:0 lds
    buffer_load_dwordx4 v4, s[52:55], s43 offen offset:1024 lds
    buffer_load_dwordx4 v5, s[52:55], s43 offen offset:2048 lds
    buffer_load_dwordx4 v6, s[52:55], s43 offen offset:3072 lds
    s_add_u32 s43, s43, 36864
    s_add_u32 m0, s44, 16384
    s_nop 0
    buffer_load_dwordx4 v3, s[52:55], s43 offen offset:0 lds
    buffer_load_dwordx4 v4, s[52:55], s43 offen offset:1024 lds
    buffer_load_dwordx4 v5, s[52:55], s43 offen offset:2048 lds
    buffer_load_dwordx4 v6, s[52:55], s43 offen offset:3072 lds
    s_add_u32 s43, s43, 36864
    s_waitcnt vmcnt(16)
    s_barrier
    s_cmp_lg_u32 s3, 0
    s_cbranch_scc1 L_t_nosig
    s_lshl_b32 s34, s7, 5
    v_mov_b32 v10, s34
    v_mov_b32 v11, 1
    s_mov_b64 exec, 1
    buffer_atomic_add v11, v10, s[92:95], 0 offen sc1
    s_mov_b64 exec, -1
L_t_nosig:
    s_add_u32 m0, s44, 32768
    s_nop 0
    buffer_load_dwordx4 v3, s[52:55], s43 offen offset:0 lds
    buffer_load_dwordx4 v4, s[52:55], s43 offen offset:1024 lds
    buffer_load_dwordx4 v5, s[52:55], s43 offen offset:2048 lds
    buffer_load_dwordx4 v6, s[52:55], s43 offen offset:3072 lds
    s_add_u32 s43, s43, 36864
    s_add_u32 m0, s44, 49152
    s_nop 0
    buffer_load_dwordx4 v3, s[52:55], s43 offen offset:0 lds
    buffer_load_dwordx4 v4, s[52:55], s43 offen offset:1024 lds
    buffer_load_dwordx4 v5, s[52:55], s43 offen offset:2048 lds
    buffer_load_dwordx4 v6, s[52:55], s43 offen offset:3072 lds
    s_add_u32 s43, s43, 36864
    s_add_u32 m0, s44, 98304
    s_nop 0
    buffer_load_dwordx4 v3, s[52:55], s43 offen offset:0 lds
    buffer_load_dwordx4 v4, s[52:55], s43 offen offset:1024 lds
    buffer_load_dwordx4 v5, s[52:55], s43 offen offset:2048 lds
    buffer_load_dwordx4 v6, s[52:55], s43 offen offset:3072 lds
    s_add_u32 s43, s43, 36864
    s_add_u32 m0, s44, 114688
    s_nop 0
    buffer_load_dwordx4 v3, s[52:55], s43 offen offset:0 lds
    buffer_load_dwordx4 v4, s[52:55], s43 offen offset:1024 lds
    buffer_load_dwordx4 v5, s[52:55], s43 offen offset:2048 lds
    buffer_load_dwordx4 v6, s[52:55], s43 offen offset:3072 lds
    s_add_u32 s43, s43, 36864
    s_add_u32 m0, s44, 131072
    s_nop 0
    buffer_load_dwordx4 v3, s[52:55], s43 offen offset:0 lds
    buffer_load_dwordx4 v4, s[52:55], s43 offen offset:1024 lds
    buffer_load_dwordx4 v5, s[52:55], s43 offen offset:2048 lds
    buffer_load_dwordx4 v6, s[52:55], s43 offen offset:3072 lds
    s_add_u32 s43, s43, 36864
    s_add_u32 m0, s44, 147456
    s_nop 0
    buffer_load_dwordx4 v3, s[52:55], s43 offen offset:0 lds
    buffer_load_dwordx4 v4, s[52:55], s43 offen offset:1024 lds
    buffer_load_dwordx4 v5, s[52:55], s43 offen offset:2048 lds
    buffer_load_dwordx4 v6, s[52:55], s43 offen offset:3072 lds
    s_add_u32 s43, s43, 36864
    s_waitcnt vmcnt(36)
    ds_read_b64_tr_b16 a[64:65], v20 offset:16384
    ds_read_b64_tr_b16 a[66:67], v20 offset:18432
    ds_read_b64_tr_b16 a[68:69], v21 offset:16384
    ds_read_b64_tr_b16 a[70:71], v21 offset:18432
    ds_read_b64_tr_b16 a[72:73], v22 offset:16384
    ds_read_b64_tr_b16 a[74:75], v22 offset:18432
    ds_read_b64_tr_b16 a[76:77], v23 offset:16384
    ds_read_b64_tr_b16 a[78:79], v23 offset:18432
    s_waitcnt vmcnt(32)
    ds_read_b64_tr_b16 a[80:81], v16 offset:0
    ds_read_b64_tr_b16 a[82:83], v16 offset:2048
    ds_read_b64_tr_b16 a[84:85], v17 offset:0
    ds_read_b64_tr_b16 a[86:87], v17 offset:2048
    ds_read_b64_tr_b16 a[88:89], v18 offset:0
    ds_read_b64_tr_b16 a[90:91], v18 offset:2048
    ds_read_b64_tr_b16 a[92:93], v19 offset:0
    ds_read_b64_tr_b16 a[94:95], v19 offset:2048
    s_waitcnt lgkmcnt(8)
    s_add_u32 m0, s44, 81920
    s_nop 0
    buffer_load_dwordx4 v3, s[52:55], s43 offen offset:0 lds
    buffer_load_dwordx4 v4, s[52:55], s43 offen offset:1024 lds
    buffer_load_dwordx4 v5, s[52:55], s43 offen offset:2048 lds
    buffer_load_dwordx4 v6, s[52:55], s43 offen offset:3072 lds
    s_add_u32 s43, s43, 36864
    s_waitcnt vmcnt(32)
    ds_read_b64_tr_b16 a[96:97], v20 offset:0
    ds_read_b64_tr_b16 a[98:99], v20 offset:2048
    ds_read_b64_tr_b16 a[244:245], v21 offset:0
    ds_read_b64_tr_b16 a[246:247], v21 offset:2048
    ds_read_b64_tr_b16 a[248:249], v22 offset:0
    ds_read_b64_tr_b16 a[250:251], v22 offset:2048
    ds_read_b64_tr_b16 a[252:253], v23 offset:0
    ds_read_b64_tr_b16 a[254:255], v23 offset:2048
    s_waitcnt lgkmcnt(8)
    s_add_u32 m0, s44, 0
    s_nop 0
    buffer_load_dwordx4 v3, s[52:55], s43 offen offset:0 lds
    buffer_load_dwordx4 v4, s[52:55], s43 offen offset:1024 lds
    buffer_load_dwordx4 v5, s[52:55], s43 offen offset:2048 lds
    buffer_load_dwordx4 v6, s[52:55], s43 offen offset:3072 lds
    s_add_u32 s43, s43, 36864
    s_waitcnt vmcnt(32)
    ds_read_b64_tr_b16 v[160:161], v16 offset:16384
    ds_read_b64_tr_b16 v[162:163], v16 offset:18432
    ds_read_b64_tr_b16 v[164:165], v17 offset:16384
    ds_read_b64_tr_b16 v[166:167], v17 offset:18432
    ds_read_b64_tr_b16 v[168:169], v18 offset:16384
    ds_read_b64_tr_b16 v[170:171], v18 offset:18432
    ds_read_b64_tr_b16 v[172:173], v19 offset:16384
    ds_read_b64_tr_b16 v[174:175], v19 offset:18432
    s_waitcnt lgkmcnt(8)
    s_add_u32 m0, s44, 65536
    s_nop 0
    buffer_load_dwordx4 v3, s[52:55], s43 offen offset:0 lds
    buffer_load_dwordx4 v4, s[52:55], s43 offen offset:1024 lds
    buffer_load_dwordx4 v5, s[52:55], s43 offen offset:2048 lds
    buffer_load_dwordx4 v6, s[52:55], s43 offen offset:3072 lds
    s_add_u32 s43, s43, 36864
    s_waitcnt vmcnt(32)
    ds_read_b64_tr_b16 v[176:177], v16 offset:32768
    ds_read_b64_tr_b16 v[178:179], v16 offset:34816
    ds_read_b64_tr_b16 v[180:181], v17 offset:32768
    ds_read_b64_tr_b16 v[182:183], v17 offset:34816
    ds_read_b64_tr_b16 v[184:185], v18 offset:32768
    ds_read_b64_tr_b16 v[186:187], v18 offset:34816
    ds_read_b64_tr_b16 v[188:189], v19 offset:32768
    ds_read_b64_tr_b16 v[190:191], v19 offset:34816
    s_waitcnt lgkmcnt(8)
    s_add_u32 m0, s44, 16384
    s_nop 0
    buffer_load_dwordx4 v3, s[52:55], s43 offen offset:0 lds
    buffer_load_dwordx4 v4, s[52:55], s43 offen offset:1024 lds
    buffer_load_dwordx4 v5, s[52:55], s43 offen offset:2048 lds
    buffer_load_dwordx4 v6, s[52:55], s43 offen offset:3072 lds
    s_add_u32 s43, s43, 36864
    s_waitcnt vmcnt(32)
    ds_read_b64_tr_b16 v[192:193], v16 offset:49152
    ds_read_b64_tr_b16 v[194:195], v16 offset:51200
    ds_read_b64_tr_b16 v[196:197], v17 offset:49152
    ds_read_b64_tr_b16 v[198:199], v17 offset:51200
    ds_read_b64_tr_b16 v[200:201], v18 offset:49152
    ds_read_b64_tr_b16 v[202:203], v18 offset:51200
    ds_read_b64_tr_b16 v[204:205], v19 offset:49152
    ds_read_b64_tr_b16 v[206:207], v19 offset:51200
    s_waitcnt lgkmcnt(8)
    s_add_u32 m0, s44, 32768
    s_nop 0
    buffer_load_dwordx4 v3, s[52:55], s43 offen offset:0 lds
    buffer_load_dwordx4 v4, s[52:55], s43 offen offset:1024 lds
    buffer_load_dwordx4 v5, s[52:55], s43 offen offset:2048 lds
    buffer_load_dwordx4 v6, s[52:55], s43 offen offset:3072 lds
    s_add_u32 s43, s43, 36864
    s_waitcnt vmcnt(32)
    ds_read_b64_tr_b16 v[208:209], v20 offset:32768
    ds_read_b64_tr_b16 v[210:211], v20 offset:34816
    ds_read_b64_tr_b16 v[212:213], v21 offset:32768
    ds_read_b64_tr_b16 v[214:215], v21 offset:34816
    ds_read_b64_tr_b16 v[216:217], v22 offset:32768
    ds_read_b64_tr_b16 v[218:219], v22 offset:34816
    ds_read_b64_tr_b16 v[220:221], v23 offset:32768
    ds_read_b64_tr_b16 v[222:223], v23 offset:34816
    s_waitcnt lgkmcnt(8)
    s_add_u32 m0, s44, 49152
    s_nop 0
    buffer_load_dwordx4 v3, s[52:55], s43 offen offset:0 lds
    buffer_load_dwordx4 v4, s[52:55], s43 offen offset:1024 lds
    buffer_load_dwordx4 v5, s[52:55], s43 offen offset:2048 lds
    buffer_load_dwordx4 v6, s[52:55], s43 offen offset:3072 lds
    s_add_u32 s43, s43, 36864
    s_cmp_lg_u32 s3, 0
    s_cbranch_scc1 L_t_np0
    s_mov_b64 exec, 3
    buffer_load_dword v12, v1, s[92:95], 0 offen sc1
    s_mov_b64 exec, -1
L_t_np0:
    s_waitcnt vmcnt(32)
    ds_read_b64_tr_b16 v[224:225], v20 offset:49152
    ds_read_b64_tr_b16 v[226:227], v20 offset:51200
    ds_read_b64_tr_b16 v[228:229], v21 offset:49152
    ds_read_b64_tr_b16 v[230:231], v21 offset:51200
    ds_read_b64_tr_b16 v[232:233], v22 offset:49152
    ds_read_b64_tr_b16 v[234:235], v22 offset:51200
    ds_read_b64_tr_b16 v[236:237], v23 offset:49152
    ds_read_b64_tr_b16 v[238:239], v23 offset:51200
    s_waitcnt lgkmcnt(8)
    s_add_u32 m0, s44, 98304
    s_nop 0
    buffer_load_dwordx4 v3, s[52:55], s43 offen offset:0 lds
    buffer_load_dwordx4 v4, s[52:55], s43 offen offset:1024 lds
    buffer_load_dwordx4 v5, s[52:55], s43 offen offset:2048 lds
    buffer_load_dwordx4 v6, s[52:55], s43 offen offset:3072 lds
    s_add_u32 s43, s43, 36864
    s_waitcnt vmcnt(32)
    ds_read_b64_tr_b16 v[240:241], v24 offset:0
    ds_read_b64_tr_b16 v[242:243], v24 offset:2048
    ds_read_b64_tr_b16 v[244:245], v25 offset:0
    ds_read_b64_tr_b16 v[246:247], v25 offset:2048
    ds_read_b64_tr_b16 v[248:249], v26 offset:0
    ds_read_b64_tr_b16 v[250:251], v26 offset:2048
    ds_read_b64_tr_b16 v[252:253], v27 offset:0
    ds_read_b64_tr_b16 v[254:255], v27 offset:2048
    s_waitcnt lgkmcnt(8)
    s_add_u32 m0, s44, 114688
    s_nop 0
    buffer_load_dwordx4 v3, s[52:55], s43 offen offset:0 lds
    buffer_load_dwordx4 v4, s[52:55], s43 offen offset:1024 lds
    buffer_load_dwordx4 v5, s[52:55], s43 offen offset:2048 lds
    buffer_load_dwordx4 v6, s[52:55], s43 offen offset:3072 lds
    s_add_u32 s43, s43, 36864
    s_waitcnt lgkmcnt(0)
    s_add_u32 m0, s44, 131072
    s_nop 0
    buffer_load_dwordx4 v3, s[52:55], s43 offen offset:0 lds
    buffer_load_dwordx4 v4, s[52:55], s43 offen offset:1024 lds
    buffer_load_dwordx4 v5, s[52:55], s43 offen offset:2048 lds
    buffer_load_dwordx4 v6, s[52:55], s43 offen offset:3072 lds
    s_add_u32 s43, s43, 36864
    s_cmp_lg_u32 s3, 0
    s_cbranch_scc1 L_t_np1
    s_mov_b64 exec, 3
    buffer_load_dword v13, v1, s[92:95], 0 offen sc1
    s_mov_b64 exec, -1
L_t_np1:
    s_cmp_lg_u32 s3, 0
    s_cbranch_scc1 L_t_go
    s_mov_b64 exec, 3
    s_waitcnt vmcnt(13)
    v_cmp_gt_u32 vcc, 32, v12
    s_cbranch_vccz L_t_go
    s_waitcnt vmcnt(0)
    v_cmp_gt_u32 vcc, 32, v13
    s_cbranch_vccz L_t_go
    s_mov_b32 s37, 0
L_t_poll:
    buffer_load_dword v14, v1, s[92:95], 0 offen sc1
    s_add_u32 s37, s37, 1
    s_waitcnt vmcnt(0)
    s_cmp_gt_u32 s37, 0x40000
    s_cbranch_scc1 L_t_go
    v_cmp_gt_u32 vcc, 32, v14
    s_cbranch_vccnz L_t_poll
L_t_go:
    s_mov_b64 exec, -1
    s_barrier
    buffer_load_dwordx4 v[76:79], v7, s[24:27], s42 offen sc1
    buffer_load_dwordx4 v[80:83], v8, s[24:27], s42 offen sc1
    buffer_load_dwordx4 v[84:87], v9, s[24:27], s42 offen sc1
    s_add_u32 s42, s42, 1024
    buffer_load_dwordx4 v[88:91], v7, s[24:27], s42 offen sc1
    buffer_load_dwordx4 v[92:95], v8, s[24:27], s42 offen sc1
    buffer_load_dwordx4 v[96:99], v9, s[24:27], s42 offen sc1
    s_add_u32 s42, s42, 1024
    buffer_load_dwordx4 v[100:103], v7, s[24:27], s42 offen sc1
    buffer_load_dwordx4 v[104:107], v8, s[24:27], s42 offen sc1
    buffer_load_dwordx4 v[108:111], v9, s[24:27], s42 offen sc1
    s_add_u32 s42, s42, 1024
    buffer_load_dwordx4 v[112:115], v7, s[24:27], s42 offen sc1
    buffer_load_dwordx4 v[116:119], v8, s[24:27], s42 offen sc1
    buffer_load_dwordx4 v[120:123], v9, s[24:27], s42 offen sc1
    s_add_u32 s42, s42, 1024
    buffer_load_dwordx4 v[124:127], v7, s[24:27], s42 offen sc1
    buffer_load_dwordx4 v[128:131], v8, s[24:27], s42 offen sc1
    buffer_load_dwordx4 v[132:135], v9, s[24:27], s42 offen sc1
    s_add_u32 s42, s42, 1024
    s_waitcnt vmcnt(12)
    v_mfma_f32_16x16x32_bf16 v[28:31], a[228:231], v[76:79], 0
    v_mfma_f32_16x16x32_bf16 v[40:43], a[232:235], v[76:79], 0
    v_mfma_f32_16x16x32_bf16 v[52:55], a[236:239], v[76:79], 0
    v_mfma_f32_16x16x32_bf16 v[64:67], a[240:243], v[76:79], 0
    v_mfma_f32_16x16x32_bf16 v[32:35], a[228:231], v[80:83], 0
    v_mfma_f32_16x16x32_bf16 v[44:47], a[232:235], v[80:83], 0
    buffer_load_dwordx4 v[76:79], v7, s[24:27], s42 offen sc1
    v_mfma_f32_16x16x32_bf16 v[56:59], a[236:239], v[80:83], 0
    v_mfma_f32_16x16x32_bf16 v[68:71], a[240:243], v[80:83], 0
    v_mfma_f32_16x16x32_bf16 v[36:39], a[228:231], v[84:87], 0
    buffer_load_dwordx4 v[80:83], v8, s[24:27], s42 offen sc1
    v_mfma_f32_16x16x32_bf16 v[48:51], a[232:235], v[84:87], 0
    v_mfma_f32_16x16x32_bf16 v[60:63], a[236:239], v[84:87], 0
    v_mfma_f32_16x16x32_bf16 v[72:75], a[240:243], v[84:87], 0
    buffer_load_dwordx4 v[84:87], v9, s[24:27], s42 offen sc1
    s_add_u32 s42, s42, 1024
    s_waitcnt vmcnt(12)
    v_mfma_f32_16x16x32_bf16 v[28:31], a[100:103], v[88:91], v[28:31]
    v_mfma_f32_16x16x32_bf16 v[40:43], a[104:107], v[88:91], v[40:43]
    v_mfma_f32_16x16x32_bf16 v[52:55], a[108:111], v[88:91], v[52:55]
    v_mfma_f32_16x16x32_bf16 v[64:67], a[112:115], v[88:91], v[64:67]
    v_mfma_f32_16x16x32_bf16 v[32:35], a[100:103], v[92:95], v[32:35]
    v_mfma_f32_16x16x32_bf16 v[44:47], a[104:107], v[92:95], v[44:47]
    buffer_load_dwordx4 v[88:91], v7, s[24:27], s42 offen sc1
    v_mfma_f32_16x16x32_bf16 v[56:59], a[108:111], v[92:95], v[56:59]
    v_mfma_f32_16x16x32_bf16 v[68:71], a[112:115], v[92:95], v[68:71]
    v_mfma_f32_16x16x32_bf16 v[36:39], a[100:103], v[96:99], v[36:39]
    buffer_load_dwordx4 v[92:95], v8, s[24:27], s42 offen sc1
    v_mfma_f32_16x16x32_bf16 v[48:51], a[104:107], v[96:99], v[48:51]
    v_mfma_f32_16x16x32_bf16 v[60:63], a[108:111], v[96:99], v[60:63]
    v_mfma_f32_16x16x32_bf16 v[72:75], a[112:115], v[96:99], v[72:75]
    buffer_load_dwordx4 v[96:99], v9, s[24:27], s42 offen sc1
    s_add_u32 s42, s42, 1024
    s_waitcnt vmcnt(12)
    v_mfma_f32_16x16x32_bf16 v[28:31], a[116:119], v[100:103], v[28:31]
    v_mfma_f32_16x16x32_bf16 v[40:43], a[120:123], v[100:103], v[40:43]
    v_mfma_f32_16x16x32_bf16 v[52:55], a[124:127], v[100:103], v[52:55]
    v_mfma_f32_16x16x32_bf16 v[64:67], a[128:131], v[100:103], v[64:67]
    v_mfma_f32_16x16x32_bf16 v[32:35], a[116:119], v[104:107], v[32:35]
    v_mfma_f32_16x16x32_bf16 v[44:47], a[120:123], v[104:107], v[44:47]
    buffer_load_dwordx4 v[100:103], v7, s[24:27], s42 offen sc1
    v_mfma_f32_16x16x32_bf16 v[56:59], a[124:127], v[104:107], v[56:59]
    v_mfma_f32_16x16x32_bf16 v[68:71], a[128:131], v[104:107], v[68:71]
    v_mfma_f32_16x16x32_bf16 v[36:39], a[116:119], v[108:111], v[36:39]
    buffer_load_dwordx4 v[104:107], v8, s[24:27], s42 offen sc1
    v_mfma_f32_16x16x32_bf16 v[48:51], a[120:123], v[108:111], v[48:51]
    v_mfma_f32_16x16x32_bf16 v[60:63], a[124:127], v[108:111], v[60:63]
    v_mfma_f32_16x16x32_bf16 v[72:75], a[128:131], v[108:111], v[72:75]
    buffer_load_dwordx4 v[108:111], v9, s[24:27], s42 offen sc1
    s_add_u32 s42, s42, 1024
    s_waitcnt vmcnt(12)
    v_mfma_f32_16x16x32_bf16 v[28:31], a[132:135], v[112:115], v[28:31]
    v_mfma_f32_16x16x32_bf16 v[40:43], a[136:139], v[112:115], v[40:43]
    v_mfma_f32_16x16x32_bf16 v[52:55], a[140:143], v[112:115], v[52:55]
    v_mfma_f32_16x16x32_bf16 v[64:67], a[144:147], v[112:115], v[64:67]
    v_mfma_f32_16x16x32_bf16 v[32:35], a[132:135], v[116:119], v[32:35]
    v_mfma_f32_16x16x32_bf16 v[44:47], a[136:139], v[116:119], v[44:47]
    buffer_load_dwordx4 v[112:115], v7, s[24:27], s42 offen sc1
    v_mfma_f32_16x16x32_bf16 v[56:59], a[140:143], v[116:119], v[56:59]
    v_mfma_f32_16x16x32_bf16 v[68:71], a[144:147], v[116:119], v[68:71]
    v_mfma_f32_16x16x32_bf16 v[36:39], a[132:135], v[120:123], v[36:39]
    buffer_load_dwordx4 v[116:119], v8, s[24:27], s42 offen sc1
    v_mfma_f32_16x16x32_bf16 v[48:51], a[136:139], v[120:123], v[48:51]
    v_mfma_f32_16x16x32_bf16 v[60:63], a[140:143], v[120:123], v[60:63]
    v_mfma_f32_16x16x32_bf16 v[72:75], a[144:147], v[120:123], v[72:75]
    buffer_load_dwordx4 v[120:123], v9, s[24:27], s42 offen sc1
    s_add_u32 s42, s42, 1024
    s_waitcnt vmcnt(12)
    v_mfma_f32_16x16x32_bf16 v[28:31], a[164:167], v[124:127], v[28:31]
    v_mfma_f32_16x16x32_bf16 v[40:43], a[168:171], v[124:127], v[40:43]
    v_mfma_f32_16x16x32_bf16 v[52:55], a[172:175], v[124:127], v[52:55]
    v_mfma_f32_16x16x32_bf16 v[64:67], a[176:179], v[124:127], v[64:67]
    v_mfma_f32_16x16x32_bf16 v[32:35], a[164:167], v[128:131], v[32:35]
    v_mfma_f32_16x16x32_bf16 v[44:47], a[168:171], v[128:131], v[44:47]
    buffer_load_dwordx4 v[124:127], v7, s[24:27], s42 offen sc1
    v_mfma_f32_16x16x32_bf16 v[56:59], a[172:175], v[128:131], v[56:59]
    v_mfma_f32_16x16x32_bf16 v[68:71], a[176:179], v[128:131], v[68:71]
    v_mfma_f32_16x16x32_bf16 v[36:39], a[164:167], v[132:135], v[36:39]
    buffer_load_dwordx4 v[128:131], v8, s[24:27], s42 offen sc1
    v_mfma_f32_16x16x32_bf16 v[48:51], a[168:171], v[132:135], v[48:51]
    v_mfma_f32_16x16x32_bf16 v[60:63], a[172:175], v[132:135], v[60:63]
    v_mfma_f32_16x16x32_bf16 v[72:75], a[176:179], v[132:135], v[72:75]
    buffer_load_dwordx4 v[132:135], v9, s[24:27], s42 offen sc1
    s_add_u32 s42, s42, 1024
    s_waitcnt vmcnt(12)
    v_mfma_f32_16x16x32_bf16 v[28:31], a[180:183], v[76:79], v[28:31]
    v_mfma_f32_16x16x32_bf16 v[40:43], a[184:187], v[76:79], v[40:43]
    v_mfma_f32_16x16x32_bf16 v[52:55], a[188:191], v[76:79], v[52:55]
    v_mfma_f32_16x16x32_bf16 v[64:67], a[192:195], v[76:79], v[64:67]
    v_mfma_f32_16x16x32_bf16 v[32:35], a[180:183], v[80:83], v[32:35]
    v_mfma_f32_16x16x32_bf16 v[44:47], a[184:187], v[80:83], v[44:47]
    buffer_load_dwordx4 v[76:79], v7, s[24:27], s42 offen sc1
    v_mfma_f32_16x16x32_bf16 v[56:59], a[188:191], v[80:83], v[56:59]
    v_mfma_f32_16x16x32_bf16 v[68:71], a[192:195], v[80:83], v[68:71]
    v_mfma_f32_16x16x32_bf16 v[36:39], a[180:183], v[84:87], v[36:39]
    buffer_load_dwordx4 v[80:83], v8, s[24:27], s42 offen sc1
    v_mfma_f32_16x16x32_bf16 v[48:51], a[184:187], v[84:87], v[48:51]
    v_mfma_f32_16x16x32_bf16 v[60:63], a[188:191], v[84:87], v[60:63]
    v_mfma_f32_16x16x32_bf16 v[72:75], a[192:195], v[84:87], v[72:75]
    buffer_load_dwordx4 v[84:87], v9, s[24:27], s42 offen sc1
    s_add_u32 s42, s42, 1024
    s_waitcnt vmcnt(12)
    v_mfma_f32_16x16x32_bf16 v[28:31], a[148:151], v[88:91], v[28:31]
    v_mfma_f32_16x16x32_bf16 v[40:43], a[152:155], v[88:91], v[40:43]
    v_mfma_f32_16x16x32_bf16 v[52:55], a[156:159], v[88:91], v[52:55]
    v_mfma_f32_16x16x32_bf16 v[64:67], a[160:163], v[88:91], v[64:67]
    v_mfma_f32_16x16x32_bf16 v[32:35], a[148:151], v[92:95], v[32:35]
    v_mfma_f32_16x16x32_bf16 v[44:47], a[152:155], v[92:95], v[44:47]
    buffer_load_dwordx4 v[88:91], v7, s[24:27], s42 offen sc1
    v_mfma_f32_16x16x32_bf16 v[56:59], a[156:159], v[92:95], v[56:59]
    v_mfma_f32_16x16x32_bf16 v[68:71], a[160:163], v[92:95], v[68:71]
    v_mfma_f32_16x16x32_bf16 v[36:39], a[148:151], v[96:99], v[36:39]
    buffer_load_dwordx4 v[92:95], v8, s[24:27], s42 offen sc1
    v_mfma_f32_16x16x32_bf16 v[48:51], a[152:155], v[96:99], v[48:51]
    v_mfma_f32_16x16x32_bf16 v[60:63], a[156:159], v[96:99], v[60:63]
    v_mfma_f32_16x16x32_bf16 v[72:75], a[160:163], v[96:99], v[72:75]
    buffer_load_dwordx4 v[96:99], v9, s[24:27], s42 offen sc1
    s_add_u32 s42, s42, 1024
    s_waitcnt vmcnt(12)
    v_mfma_f32_16x16x32_bf16 v[28:31], a[212:215], v[100:103], v[28:31]
    v_mfma_f32_16x16x32_bf16 v[40:43], a[216:219], v[100:103], v[40:43]
    v_mfma_f32_16x16x32_bf16 v[52:55], a[220:223], v[100:103], v[52:55]
    v_mfma_f32_16x16x32_bf16 v[64:67], a[224:227], v[100:103], v[64:67]
    v_mfma_f32_16x16x32_bf16 v[32:35], a[212:215], v[104:107], v[32:35]
    v_mfma_f32_16x16x32_bf16 v[44:47], a[216:219], v[104:107], v[44:47]
    buffer_load_dwordx4 v[100:103], v7, s[24:27], s42 offen sc1
    v_mfma_f32_16x16x32_bf16 v[56:59], a[220:223], v[104:107], v[56:59]
    v_mfma_f32_16x16x32_bf16 v[68:71], a[224:227], v[104:107], v[68:71]
    v_mfma_f32_16x16x32_bf16 v[36:39], a[212:215], v[108:111], v[36:39]
    buffer_load_dwordx4 v[104:107], v8, s[24:27], s42 offen sc1
    v_mfma_f32_16x16x32_bf16 v[48:51], a[216:219], v[108:111], v[48:51]
    v_mfma_f32_16x16x32_bf16 v[60:63], a[220:223], v[108:111], v[60:63]
    v_mfma_f32_16x16x32_bf16 v[72:75], a[224:227], v[108:111], v[72:75]
    buffer_load_dwordx4 v[108:111], v9, s[24:27], s42 offen sc1
    s_add_u32 s42, s42, 1024
    s_waitcnt vmcnt(12)
    v_mfma_f32_16x16x32_bf16 v[28:31], a[196:199], v[112:115], v[28:31]
    v_mfma_f32_16x16x32_bf16 v[40:43], a[200:203], v[112:115], v[40:43]
    v_mfma_f32_16x16x32_bf16 v[52:55], a[204:207], v[112:115], v[52:55]
    v_mfma_f32_16x16x32_bf16 v[64:67], a[208:211], v[112:115], v[64:67]
    v_mfma_f32_16x16x32_bf16 v[32:35], a[196:199], v[116:119], v[32:35]
    v_mfma_f32_16x16x32_bf16 v[44:47], a[200:203], v[116:119], v[44:47]
    buffer_load_dwordx4 v[112:115], v7, s[24:27], s42 offen sc1
    v_mfma_f32_16x16x32_bf16 v[56:59], a[204:207], v[116:119], v[56:59]
    v_mfma_f32_16x16x32_bf16 v[68:71], a[208:211], v[116:119], v[68:71]
    v_mfma_f32_16x16x32_bf16 v[36:39], a[196:199], v[120:123], v[36:39]
    buffer_load_dwordx4 v[116:119], v8, s[24:27], s42 offen sc1
    v_mfma_f32_16x16x32_bf16 v[48:51], a[200:203], v[120:123], v[48:51]
    v_mfma_f32_16x16x32_bf16 v[60:63], a[204:207], v[120:123], v[60:63]
    v_mfma_f32_16x16x32_bf16 v[72:75], a[208:211], v[120:123], v[72:75]
    buffer_load_dwordx4 v[120:123], v9, s[24:27], s42 offen sc1
    s_add_u32 s42, s42, 1024
    s_waitcnt vmcnt(12)
    v_mfma_f32_16x16x32_bf16 v[28:31], a[0:3], v[124:127], v[28:31]
    v_mfma_f32_16x16x32_bf16 v[40:43], a[4:7], v[124:127], v[40:43]
    v_mfma_f32_16x16x32_bf16 v[52:55], a[8:11], v[124:127], v[52:55]
    v_mfma_f32_16x16x32_bf16 v[64:67], a[12:15], v[124:127], v[64:67]
    v_mfma_f32_16x16x32_bf16 v[32:35], a[0:3], v[128:131], v[32:35]
    v_mfma_f32_16x16x32_bf16 v[44:47], a[4:7], v[128:131], v[44:47]
    buffer_load_dwordx4 v[124:127], v7, s[24:27], s42 offen sc1
    v_mfma_f32_16x16x32_bf16 v[56:59], a[8:11], v[128:131], v[56:59]
    v_mfma_f32_16x16x32_bf16 v[68:71], a[12:15], v[128:131], v[68:71]
    v_mfma_f32_16x16x32_bf16 v[36:39], a[0:3], v[132:135], v[36:39]
    buffer_load_dwordx4 v[128:131], v8, s[24:27], s42 offen sc1
    v_mfma_f32_16x16x32_bf16 v[48:51], a[4:7], v[132:135], v[48:51]
    v_mfma_f32_16x16x32_bf16 v[60:63], a[8:11], v[132:135], v[60:63]
    v_mfma_f32_16x16x32_bf16 v[72:75], a[12:15], v[132:135], v[72:75]
    buffer_load_dwordx4 v[132:135], v9, s[24:27], s42 offen sc1
    s_add_u32 s42, s42, 1024
    s_waitcnt vmcnt(12)
    v_mfma_f32_16x16x32_bf16 v[28:31], a[16:19], v[76:79], v[28:31]
    v_mfma_f32_16x16x32_bf16 v[40:43], a[20:23], v[76:79], v[40:43]
    v_mfma_f32_16x16x32_bf16 v[52:55], a[24:27], v[76:79], v[52:55]
    v_mfma_f32_16x16x32_bf16 v[64:67], a[28:31], v[76:79], v[64:67]
    v_mfma_f32_16x16x32_bf16 v[32:35], a[16:19], v[80:83], v[32:35]
    v_mfma_f32_16x16x32_bf16 v[44:47], a[20:23], v[80:83], v[44:47]
    buffer_load_dwordx4 v[76:79], v7, s[24:27], s42 offen sc1
    v_mfma_f32_16x16x32_bf16 v[56:59], a[24:27], v[80:83], v[56:59]
    v_mfma_f32_16x16x32_bf16 v[68:71], a[28:31], v[80:83], v[68:71]
    v_mfma_f32_16x16x32_bf16 v[36:39], a[16:19], v[84:87], v[36:39]
    buffer_load_dwordx4 v[80:83], v8, s[24:27], s42 offen sc1
    v_mfma_f32_16x16x32_bf16 v[48:51], a[20:23], v[84:87], v[48:51]
    v_mfma_f32_16x16x32_bf16 v[60:63], a[24:27], v[84:87], v[60:63]
    v_mfma_f32_16x16x32_bf16 v[72:75], a[28:31], v[84:87], v[72:75]
    buffer_load_dwordx4 v[84:87], v9, s[24:27], s42 offen sc1
    s_add_u32 s42, s42, 1024
    s_waitcnt vmcnt(12)
    v_mfma_f32_16x16x32_bf16 v[28:31], a[32:35], v[88:91], v[28:31]
    v_mfma_f32_16x16x32_bf16 v[40:43], a[36:39], v[88:91], v[40:43]
    v_mfma_f32_16x16x32_bf16 v[52:55], a[40:43], v[88:91], v[52:55]
    v_mfma_f32_16x16x32_bf16 v[64:67], a[44:47], v[88:91], v[64:67]
    v_mfma_f32_16x16x32_bf16 v[32:35], a[32:35], v[92:95], v[32:35]
    v_mfma_f32_16x16x32_bf16 v[44:47], a[36:39], v[92:95], v[44:47]
    buffer_load_dwordx4 v[88:91], v7, s[24:27], s42 offen sc1
    v_mfma_f32_16x16x32_bf16 v[56:59], a[40:43], v[92:95], v[56:59]
    v_mfma_f32_16x16x32_bf16 v[68:71], a[44:47], v[92:95], v[68:71]
    v_mfma_f32_16x16x32_bf16 v[36:39], a[32:35], v[96:99], v[36:39]
    buffer_load_dwordx4 v[92:95], v8, s[24:27], s42 offen sc1
    v_mfma_f32_16x16x32_bf16 v[48:51], a[36:39], v[96:99], v[48:51]
    v_mfma_f32_16x16x32_bf16 v[60:63], a[40:43], v[96:99], v[60:63]
    v_mfma_f32_16x16x32_bf16 v[72:75], a[44:47], v[96:99], v[72:75]
    buffer_load_dwordx4 v[96:99], v9, s[24:27], s42 offen sc1
    s_add_u32 s42, s42, 1024
    s_waitcnt vmcnt(12)
    v_mfma_f32_16x16x32_bf16 v[28:31], a[48:51], v[100:103], v[28:31]
    v_mfma_f32_16x16x32_bf16 v[40:43], a[52:55], v[100:103], v[40:43]
    v_mfma_f32_16x16x32_bf16 v[52:55], a[56:59], v[100:103], v[52:55]
    v_mfma_f32_16x16x32_bf16 v[64:67], a[60:63], v[100:103], v[64:67]
    v_mfma_f32_16x16x32_bf16 v[32:35], a[48:51], v[104:107], v[32:35]
    v_mfma_f32_16x16x32_bf16 v[44:47], a[52:55], v[104:107], v[44:47]
    buffer_load_dwordx4 v[100:103], v7, s[24:27], s42 offen sc1
    v_mfma_f32_16x16x32_bf16 v[56:59], a[56:59], v[104:107], v[56:59]
    v_mfma_f32_16x16x32_bf16 v[68:71], a[60:63], v[104:107], v[68:71]
    v_mfma_f32_16x16x32_bf16 v[36:39], a[48:51], v[108:111], v[36:39]
    buffer_load_dwordx4 v[104:107], v8, s[24:27], s42 offen sc1
    v_mfma_f32_16x16x32_bf16 v[48:51], a[52:55], v[108:111], v[48:51]
    v_mfma_f32_16x16x32_bf16 v[60:63], a[56:59], v[108:111], v[60:63]
    v_mfma_f32_16x16x32_bf16 v[72:75], a[60:63], v[108:111], v[72:75]
    buffer_load_dwordx4 v[108:111], v9, s[24:27], s42 offen sc1
    s_add_u32 s42, s42, 1024
    s_waitcnt vmcnt(12)
    v_mfma_f32_16x16x32_bf16 v[28:31], a[64:67], v[112:115], v[28:31]
    v_mfma_f32_16x16x32_bf16 v[40:43], a[68:71], v[112:115], v[40:43]
    v_mfma_f32_16x16x32_bf16 v[52:55], a[72:75], v[112:115], v[52:55]
    v_mfma_f32_16x16x32_bf16 v[64:67], a[76:79], v[112:115], v[64:67]
    v_mfma_f32_16x16x32_bf16 v[32:35], a[64:67], v[116:119], v[32:35]
    v_mfma_f32_16x16x32_bf16 v[44:47], a[68:71], v[116:119], v[44:47]
    buffer_load_dwordx4 v[112:115], v7, s[24:27], s42 offen sc1
    v_mfma_f32_16x16x32_bf16 v[56:59], a[72:75], v[116:119], v[56:59]
    v_mfma_f32_16x16x32_bf16 v[68:71], a[76:79], v[116:119], v[68:71]
    v_mfma_f32_16x16x32_bf16 v[36:39], a[64:67], v[120:123], v[36:39]
    buffer_load_dwordx4 v[116:119], v8, s[24:27], s42 offen sc1
    v_mfma_f32_16x16x32_bf16 v[48:51], a[68:71], v[120:123], v[48:51]
    v_mfma_f32_16x16x32_bf16 v[60:63], a[72:75], v[120:123], v[60:63]
    v_mfma_f32_16x16x32_bf16 v[72:75], a[76:79], v[120:123], v[72:75]
    buffer_load_dwordx4 v[120:123], v9, s[24:27], s42 offen sc1
    s_add_u32 s42, s42, 1024
    s_waitcnt vmcnt(12)
    v_mfma_f32_16x16x32_bf16 v[28:31], a[80:83], v[124:127], v[28:31]
    v_mfma_f32_16x16x32_bf16 v[40:43], a[84:87], v[124:127], v[40:43]
    v_mfma_f32_16x16x32_bf16 v[52:55], a[88:91], v[124:127], v[52:55]
    v_mfma_f32_16x16x32_bf16 v[64:67], a[92:95], v[124:127], v[64:67]
    v_mfma_f32_16x16x32_bf16 v[32:35], a[80:83], v[128:131], v[32:35]
    v_mfma_f32_16x16x32_bf16 v[44:47], a[84:87], v[128:131], v[44:47]
    buffer_load_dwordx4 v[124:127], v7, s[24:27], s42 offen sc1
    v_mfma_f32_16x16x32_bf16 v[56:59], a[88:91], v[128:131], v[56:59]
    v_mfma_f32_16x16x32_bf16 v[68:71], a[92:95], v[128:131], v[68:71]
    v_mfma_f32_16x16x32_bf16 v[36:39], a[80:83], v[132:135], v[36:39]
    buffer_load_dwordx4 v[128:131], v8, s[24:27], s42 offen sc1
    v_mfma_f32_16x16x32_bf16 v[48:51], a[84:87], v[132:135], v[48:51]
    v_mfma_f32_16x16x32_bf16 v[60:63], a[88:91], v[132:135], v[60:63]
    v_mfma_f32_16x16x32_bf16 v[72:75], a[92:95], v[132:135], v[72:75]
    buffer_load_dwordx4 v[132:135], v9, s[24:27], s42 offen sc1
    s_add_u32 s42, s42, 1024
    s_waitcnt vmcnt(12)
    v_mfma_f32_16x16x32_bf16 v[28:31], a[96:99], v[76:79], v[28:31]
    v_mfma_f32_16x16x32_bf16 v[40:43], a[244:247], v[76:79], v[40:43]
    v_mfma_f32_16x16x32_bf16 v[52:55], a[248:251], v[76:79], v[52:55]
    v_mfma_f32_16x16x32_bf16 v[64:67], a[252:255], v[76:79], v[64:67]
    v_mfma_f32_16x16x32_bf16 v[32:35], a[96:99], v[80:83], v[32:35]
    v_mfma_f32_16x16x32_bf16 v[44:47], a[244:247], v[80:83], v[44:47]
    buffer_load_dwordx4 v[76:79], v7, s[24:27], s42 offen sc1
    v_mfma_f32_16x16x32_bf16 v[56:59], a[248:251], v[80:83], v[56:59]
    v_mfma_f32_16x16x32_bf16 v[68:71], a[252:255], v[80:83], v[68:71]
    v_mfma_f32_16x16x32_bf16 v[36:39], a[96:99], v[84:87], v[36:39]
    buffer_load_dwordx4 v[80:83], v8, s[24:27], s42 offen sc1
    v_mfma_f32_16x16x32_bf16 v[48:51], a[244:247], v[84:87], v[48:51]
    v_mfma_f32_16x16x32_bf16 v[60:63], a[248:251], v[84:87], v[60:63]
    v_mfma_f32_16x16x32_bf16 v[72:75], a[252:255], v[84:87], v[72:75]
    buffer_load_dwordx4 v[84:87], v9, s[24:27], s42 offen sc1
    s_add_u32 s42, s42, 1024
    s_waitcnt vmcnt(12)
    v_mfma_f32_16x16x32_bf16 v[28:31], v[160:163], v[88:91], v[28:31]
    v_mfma_f32_16x16x32_bf16 v[40:43], v[164:167], v[88:91], v[40:43]
    v_mfma_f32_16x16x32_bf16 v[52:55], v[168:171], v[88:91], v[52:55]
    v_mfma_f32_16x16x32_bf16 v[64:67], v[172:175], v[88:91], v[64:67]
    v_mfma_f32_16x16x32_bf16 v[32:35], v[160:163], v[92:95], v[32:35]
    v_mfma_f32_16x16x32_bf16 v[44:47], v[164:167], v[92:95], v[44:47]
    buffer_load_dwordx4 v[88:91], v7, s[24:27], s42 offen sc1
    v_mfma_f32_16x16x32_bf16 v[56:59], v[168:171], v[92:95], v[56:59]
    v_mfma_f32_16x16x32_bf16 v[68:71], v[172:175], v[92:95], v[68:71]
    v_mfma_f32_16x16x32_bf16 v[36:39], v[160:163], v[96:99], v[36:39]
    buffer_load_dwordx4 v[92:95], v8, s[24:27], s42 offen sc1
    v_mfma_f32_16x16x32_bf16 v[48:51], v[164:167], v[96:99], v[48:51]
    v_mfma_f32_16x16x32_bf16 v[60:63], v[168:171], v[96:99], v[60:63]
    v_mfma_f32_16x16x32_bf16 v[72:75], v[172:175], v[96:99], v[72:75]
    buffer_load_dwordx4 v[96:99], v9, s[24:27], s42 offen sc1
    s_add_u32 s42, s42, 1024
    s_waitcnt vmcnt(12)
    v_mfma_f32_16x16x32_bf16 v[28:31], v[176:179], v[100:103], v[28:31]
    v_mfma_f32_16x16x32_bf16 v[40:43], v[180:183], v[100:103], v[40:43]
    v_mfma_f32_16x16x32_bf16 v[52:55], v[184:187], v[100:103], v[52:55]
    v_mfma_f32_16x16x32_bf16 v[64:67], v[188:191], v[100:103], v[64:67]
    v_mfma_f32_16x16x32_bf16 v[32:35], v[176:179], v[104:107], v[32:35]
    v_mfma_f32_16x16x32_bf16 v[44:47], v[180:183], v[104:107], v[44:47]
    buffer_load_dwordx4 v[100:103], v7, s[24:27], s42 offen sc1
    v_mfma_f32_16x16x32_bf16 v[56:59], v[184:187], v[104:107], v[56:59]
    v_mfma_f32_16x16x32_bf16 v[68:71], v[188:191], v[104:107], v[68:71]
    v_mfma_f32_16x16x32_bf16 v[36:39], v[176:179], v[108:111], v[36:39]
    buffer_load_dwordx4 v[104:107], v8, s[24:27], s42 offen sc1
    v_mfma_f32_16x16x32_bf16 v[48:51], v[180:183], v[108:111], v[48:51]
    v_mfma_f32_16x16x32_bf16 v[60:63], v[184:187], v[108:111], v[60:63]
    v_mfma_f32_16x16x32_bf16 v[72:75], v[188:191], v[108:111], v[72:75]
    buffer_load_dwordx4 v[108:111], v9, s[24:27], s42 offen sc1
    s_add_u32 s42, s42, 1024
    s_waitcnt vmcnt(12)
    v_mfma_f32_16x16x32_bf16 v[28:31], v[192:195], v[112:115], v[28:31]
    v_mfma_f32_16x16x32_bf16 v[40:43], v[196:199], v[112:115], v[40:43]
    v_mfma_f32_16x16x32_bf16 v[52:55], v[200:203], v[112:115], v[52:55]
    v_mfma_f32_16x16x32_bf16 v[64:67], v[204:207], v[112:115], v[64:67]
    v_mfma_f32_16x16x32_bf16 v[32:35], v[192:195], v[116:119], v[32:35]
    v_mfma_f32_16x16x32_bf16 v[44:47], v[196:199], v[116:119], v[44:47]
    buffer_load_dwordx4 v[112:115], v7, s[24:27], s42 offen sc1
    v_mfma_f32_16x16x32_bf16 v[56:59], v[200:203], v[116:119], v[56:59]
    v_mfma_f32_16x16x32_bf16 v[68:71], v[204:207], v[116:119], v[68:71]
    v_mfma_f32_16x16x32_bf16 v[36:39], v[192:195], v[120:123], v[36:39]
    buffer_load_dwordx4 v[116:119], v8, s[24:27], s42 offen sc1
    v_mfma_f32_16x16x32_bf16 v[48:51], v[196:199], v[120:123], v[48:51]
    v_mfma_f32_16x16x32_bf16 v[60:63], v[200:203], v[120:123], v[60:63]
    v_mfma_f32_16x16x32_bf16 v[72:75], v[204:207], v[120:123], v[72:75]
    buffer_load_dwordx4 v[120:123], v9, s[24:27], s42 offen sc1
    s_add_u32 s42, s42, 1024
    s_waitcnt vmcnt(12)
    v_mfma_f32_16x16x32_bf16 v[28:31], v[208:211], v[124:127], v[28:31]
    v_mfma_f32_16x16x32_bf16 v[40:43], v[212:215], v[124:127], v[40:43]
    v_mfma_f32_16x16x32_bf16 v[52:55], v[216:219], v[124:127], v[52:55]
    v_mfma_f32_16x16x32_bf16 v[64:67], v[220:223], v[124:127], v[64:67]
    v_mfma_f32_16x16x32_bf16 v[32:35], v[208:211], v[128:131], v[32:35]
    v_mfma_f32_16x16x32_bf16 v[44:47], v[212:215], v[128:131], v[44:47]
    buffer_load_dwordx4 v[124:127], v7, s[24:27], s42 offen sc1
    v_mfma_f32_16x16x32_bf16 v[56:59], v[216:219], v[128:131], v[56:59]
    v_mfma_f32_16x16x32_bf16 v[68:71], v[220:223], v[128:131], v[68:71]
    v_mfma_f32_16x16x32_bf16 v[36:39], v[208:211], v[132:135], v[36:39]
    buffer_load_dwordx4 v[128:131], v8, s[24:27], s42 offen sc1
    v_mfma_f32_16x16x32_bf16 v[48:51], v[212:215], v[132:135], v[48:51]
    v_mfma_f32_16x16x32_bf16 v[60:63], v[216:219], v[132:135], v[60:63]
    v_mfma_f32_16x16x32_bf16 v[72:75], v[220:223], v[132:135], v[72:75]
    buffer_load_dwordx4 v[132:135], v9, s[24:27], s42 offen sc1
    s_add_u32 s42, s42, 1024
    s_waitcnt vmcnt(12)
    v_mfma_f32_16x16x32_bf16 v[28:31], v[224:227], v[76:79], v[28:31]
    v_mfma_f32_16x16x32_bf16 v[40:43], v[228:231], v[76:79], v[40:43]
    v_mfma_f32_16x16x32_bf16 v[52:55], v[232:235], v[76:79], v[52:55]
    v_mfma_f32_16x16x32_bf16 v[64:67], v[236:239], v[76:79], v[64:67]
    v_mfma_f32_16x16x32_bf16 v[32:35], v[224:227], v[80:83], v[32:35]
    v_mfma_f32_16x16x32_bf16 v[44:47], v[228:231], v[80:83], v[44:47]
    buffer_load_dwordx4 v[76:79], v7, s[24:27], s42 offen sc1
    v_mfma_f32_16x16x32_bf16 v[56:59], v[232:235], v[80:83], v[56:59]
    v_mfma_f32_16x16x32_bf16 v[68:71], v[236:239], v[80:83], v[68:71]
    v_mfma_f32_16x16x32_bf16 v[36:39], v[224:227], v[84:87], v[36:39]
    buffer_load_dwordx4 v[80:83], v8, s[24:27], s42 offen sc1
    v_mfma_f32_16x16x32_bf16 v[48:51], v[228:231], v[84:87], v[48:51]
    v_mfma_f32_16x16x32_bf16 v[60:63], v[232:235], v[84:87], v[60:63]
    v_mfma_f32_16x16x32_bf16 v[72:75], v[236:239], v[84:87], v[72:75]
    buffer_load_dwordx4 v[84:87], v9, s[24:27], s42 offen sc1
    s_add_u32 s42, s42, 1024
    s_waitcnt vmcnt(12)
    v_mfma_f32_16x16x32_bf16 v[28:31], v[240:243], v[88:91], v[28:31]
    ds_read_b64_tr_b16 a[228:229], v24 offset:16384
    ds_read_b64_tr_b16 a[230:231], v24 offset:18432
    v_mfma_f32_16x16x32_bf16 v[40:43], v[244:247], v[88:91], v[40:43]
    ds_read_b64_tr_b16 a[232:233], v25 offset:16384
    ds_read_b64_tr_b16 a[234:235], v25 offset:18432
    v_mfma_f32_16x16x32_bf16 v[52:55], v[248:251], v[88:91], v[52:55]
    ds_read_b64_tr_b16 a[236:237], v26 offset:16384
    ds_read_b64_tr_b16 a[238:239], v26 offset:18432
    v_mfma_f32_16x16x32_bf16 v[64:67], v[252:255], v[88:91], v[64:67]
    ds_read_b64_tr_b16 a[240:241], v27 offset:16384
    ds_read_b64_tr_b16 a[242:243], v27 offset:18432
    v_mfma_f32_16x16x32_bf16 v[32:35], v[240:243], v[92:95], v[32:35]
    v_mfma_f32_16x16x32_bf16 v[44:47], v[244:247], v[92:95], v[44:47]
    buffer_load_dwordx4 v[88:91], v7, s[24:27], s42 offen sc1
    v_mfma_f32_16x16x32_bf16 v[56:59], v[248:251], v[92:95], v[56:59]
    v_mfma_f32_16x16x32_bf16 v[68:71], v[252:255], v[92:95], v[68:71]
    v_mfma_f32_16x16x32_bf16 v[36:39], v[240:243], v[96:99], v[36:39]
    buffer_load_dwordx4 v[92:95], v8, s[24:27], s42 offen sc1
    v_mfma_f32_16x16x32_bf16 v[48:51], v[244:247], v[96:99], v[48:51]
    v_mfma_f32_16x16x32_bf16 v[60:63], v[248:251], v[96:99], v[60:63]
    v_mfma_f32_16x16x32_bf16 v[72:75], v[252:255], v[96:99], v[72:75]
    buffer_load_dwordx4 v[96:99], v9, s[24:27], s42 offen sc1
    s_add_u32 s42, s42, 1024
    s_waitcnt vmcnt(12) lgkmcnt(0)
    v_mfma_f32_16x16x32_bf16 v[28:31], a[228:231], v[100:103], v[28:31]
    ds_read_b64_tr_b16 a[100:101], v20 offset:16384
    ds_read_b64_tr_b16 a[102:103], v20 offset:18432
    v_mfma_f32_16x16x32_bf16 v[40:43], a[232:235], v[100:103], v[40:43]
    ds_read_b64_tr_b16 a[104:105], v21 offset:16384
    ds_read_b64_tr_b16 a[106:107], v21 offset:18432
    v_mfma_f32_16x16x32_bf16 v[52:55], a[236:239], v[100:103], v[52:55]
    ds_read_b64_tr_b16 a[108:109], v22 offset:16384
    ds_read_b64_tr_b16 a[110:111], v22 offset:18432
    v_mfma_f32_16x16x32_bf16 v[64:67], a[240:243], v[100:103], v[64:67]
    ds_read_b64_tr_b16 a[112:113], v23 offset:16384
    ds_read_b64_tr_b16 a[114:115], v23 offset:18432
    v_mfma_f32_16x16x32_bf16 v[32:35], a[228:231], v[104:107], v[32:35]
    v_mfma_f32_16x16x32_bf16 v[44:47], a[232:235], v[104:107], v[44:47]
    buffer_load_dwordx4 v[100:103], v7, s[24:27], s42 offen sc1
    v_mfma_f32_16x16x32_bf16 v[56:59], a[236:239], v[104:107], v[56:59]
    v_mfma_f32_16x16x32_bf16 v[68:71], a[240:243], v[104:107], v[68:71]
    v_mfma_f32_16x16x32_bf16 v[36:39], a[228:231], v[108:111], v[36:39]
    buffer_load_dwordx4 v[104:107], v8, s[24:27], s42 offen sc1
    v_mfma_f32_16x16x32_bf16 v[48:51], a[232:235], v[108:111], v[48:51]
    v_mfma_f32_16x16x32_bf16 v[60:63], a[236:239], v[108:111], v[60:63]
    v_mfma_f32_16x16x32_bf16 v[72:75], a[240:243], v[108:111], v[72:75]
    buffer_load_dwordx4 v[108:111], v9, s[24:27], s42 offen sc1
    s_add_u32 s42, s42, 1024
    s_waitcnt vmcnt(12) lgkmcnt(0)
    v_mfma_f32_16x16x32_bf16 v[28:31], a[100:103], v[112:115], v[28:31]
    ds_read_b64_tr_b16 a[228:229], v16 offset:0
    ds_read_b64_tr_b16 a[230:231], v16 offset:2048
    v_mfma_f32_16x16x32_bf16 v[40:43], a[104:107], v[112:115], v[40:43]
    ds_read_b64_tr_b16 a[232:233], v17 offset:0
    ds_read_b64_tr_b16 a[234:235], v17 offset:2048
    v_mfma_f32_16x16x32_bf16 v[52:55], a[108:111], v[112:115], v[52:55]
    ds_read_b64_tr_b16 a[236:237], v18 offset:0
    ds_read_b64_tr_b16 a[238:239], v18 offset:2048
    v_mfma_f32_16x16x32_bf16 v[64:67], a[112:115], v[112:115], v[64:67]
    ds_read_b64_tr_b16 a[240:241], v19 offset:0
    ds_read_b64_tr_b16 a[242:243], v19 offset:2048
    v_mfma_f32_16x16x32_bf16 v[32:35], a[100:103], v[116:119], v[32:35]
    v_mfma_f32_16x16x32_bf16 v[44:47], a[104:107], v[116:119], v[44:47]
    buffer_load_dwordx4 v[112:115], v7, s[24:27], s42 offen sc1
    v_mfma_f32_16x16x32_bf16 v[56:59], a[108:111], v[116:119], v[56:59]
    v_mfma_f32_16x16x32_bf16 v[68:71], a[112:115], v[116:119], v[68:71]
    v_mfma_f32_16x16x32_bf16 v[36:39], a[100:103], v[120:123], v[36:39]
    buffer_load_dwordx4 v[116:119], v8, s[24:27], s42 offen sc1
    v_mfma_f32_16x16x32_bf16 v[48:51], a[104:107], v[120:123], v[48:51]
    v_mfma_f32_16x16x32_bf16 v[60:63], a[108:111], v[120:123], v[60:63]
    v_mfma_f32_16x16x32_bf16 v[72:75], a[112:115], v[120:123], v[72:75]
    buffer_load_dwordx4 v[120:123], v9, s[24:27], s42 offen sc1
    s_add_u32 s42, s42, 1024
    s_waitcnt vmcnt(12) lgkmcnt(0)
    v_mfma_f32_16x16x32_bf16 v[28:31], a[228:231], v[124:127], v[28:31]
    ds_read_b64_tr_b16 a[100:101], v20 offset:0
    ds_read_b64_tr_b16 a[102:103], v20 offset:2048
    v_mfma_f32_16x16x32_bf16 v[40:43], a[232:235], v[124:127], v[40:43]
    ds_read_b64_tr_b16 a[104:105], v21 offset:0
    ds_read_b64_tr_b16 a[106:107], v21 offset:2048
    v_mfma_f32_16x16x32_bf16 v[52:55], a[236:239], v[124:127], v[52:55]
    ds_read_b64_tr_b16 a[108:109], v22 offset:0
    ds_read_b64_tr_b16 a[110:111], v22 offset:2048
    v_mfma_f32_16x16x32_bf16 v[64:67], a[240:243], v[124:127], v[64:67]
    ds_read_b64_tr_b16 a[112:113], v23 offset:0
    ds_read_b64_tr_b16 a[114:115], v23 offset:2048
    v_mfma_f32_16x16x32_bf16 v[32:35], a[228:231], v[128:131], v[32:35]
    v_mfma_f32_16x16x32_bf16 v[44:47], a[232:235], v[128:131], v[44:47]
    buffer_load_dwordx4 v[124:127], v7, s[24:27], s42 offen sc1
    v_mfma_f32_16x16x32_bf16 v[56:59], a[236:239], v[128:131], v[56:59]
    v_mfma_f32_16x16x32_bf16 v[68:71], a[240:243], v[128:131], v[68:71]
    v_mfma_f32_16x16x32_bf16 v[36:39], a[228:231], v[132:135], v[36:39]
    buffer_load_dwordx4 v[128:131], v8, s[24:27], s42 offen sc1
    v_mfma_f32_16x16x32_bf16 v[48:51], a[232:235], v[132:135], v[48:51]
    v_mfma_f32_16x16x32_bf16 v[60:63], a[236:239], v[132:135], v[60:63]
    v_mfma_f32_16x16x32_bf16 v[72:75], a[240:243], v[132:135], v[72:75]
    buffer_load_dwordx4 v[132:135], v9, s[24:27], s42 offen sc1
    s_add_u32 s42, s42, 1024
    s_waitcnt vmcnt(12) lgkmcnt(0)
    v_mfma_f32_16x16x32_bf16 v[28:31], a[100:103], v[76:79], v[28:31]
    ds_read_b64_tr_b16 a[228:229], v16 offset:16384
    ds_read_b64_tr_b16 a[230:231], v16 offset:18432
    v_mfma_f32_16x16x32_bf16 v[40:43], a[104:107], v[76:79], v[40:43]
    ds_read_b64_tr_b16 a[232:233], v17 offset:16384
    ds_read_b64_tr_b16 a[234:235], v17 offset:18432
    v_mfma_f32_16x16x32_bf16 v[52:55], a[108:111], v[76:79], v[52:55]
    ds_read_b64_tr_b16 a[236:237], v18 offset:16384
    ds_read_b64_tr_b16 a[238:239], v18 offset:18432
    v_mfma_f32_16x16x32_bf16 v[64:67], a[112:115], v[76:79], v[64:67]
    ds_read_b64_tr_b16 a[240:241], v19 offset:16384
    ds_read_b64_tr_b16 a[242:243], v19 offset:18432
    v_mfma_f32_16x16x32_bf16 v[32:35], a[100:103], v[80:83], v[32:35]
    v_mfma_f32_16x16x32_bf16 v[44:47], a[104:107], v[80:83], v[44:47]
    buffer_load_dwordx4 v[76:79], v7, s[24:27], s42 offen sc1
    v_mfma_f32_16x16x32_bf16 v[56:59], a[108:111], v[80:83], v[56:59]
    v_mfma_f32_16x16x32_bf16 v[68:71], a[112:115], v[80:83], v[68:71]
    v_mfma_f32_16x16x32_bf16 v[36:39], a[100:103], v[84:87], v[36:39]
    buffer_load_dwordx4 v[80:83], v8, s[24:27], s42 offen sc1
    v_mfma_f32_16x16x32_bf16 v[48:51], a[104:107], v[84:87], v[48:51]
    v_mfma_f32_16x16x32_bf16 v[60:63], a[108:111], v[84:87], v[60:63]
    v_mfma_f32_16x16x32_bf16 v[72:75], a[112:115], v[84:87], v[72:75]
    buffer_load_dwordx4 v[84:87], v9, s[24:27], s42 offen sc1
    s_add_u32 s42, s42, 1024
    s_waitcnt vmcnt(12) lgkmcnt(0)
    v_mfma_f32_16x16x32_bf16 v[28:31], a[228:231], v[88:91], v[28:31]
    ds_read_b64_tr_b16 a[100:101], v16 offset:32768
    ds_read_b64_tr_b16 a[102:103], v16 offset:34816
    v_mfma_f32_16x16x32_bf16 v[40:43], a[232:235], v[88:91], v[40:43]
    ds_read_b64_tr_b16 a[104:105], v17 offset:32768
    ds_read_b64_tr_b16 a[106:107], v17 offset:34816
    v_mfma_f32_16x16x32_bf16 v[52:55], a[236:239], v[88:91], v[52:55]
    ds_read_b64_tr_b16 a[108:109], v18 offset:32768
    ds_read_b64_tr_b16 a[110:111], v18 offset:34816
    v_mfma_f32_16x16x32_bf16 v[64:67], a[240:243], v[88:91], v[64:67]
    ds_read_b64_tr_b16 a[112:113], v19 offset:32768
    ds_read_b64_tr_b16 a[114:115], v19 offset:34816
    v_mfma_f32_16x16x32_bf16 v[32:35], a[228:231], v[92:95], v[32:35]
    v_mfma_f32_16x16x32_bf16 v[44:47], a[232:235], v[92:95], v[44:47]
    buffer_load_dwordx4 v[88:91], v7, s[24:27], s42 offen sc1
    v_mfma_f32_16x16x32_bf16 v[56:59], a[236:239], v[92:95], v[56:59]
    v_mfma_f32_16x16x32_bf16 v[68:71], a[240:243], v[92:95], v[68:71]
    v_mfma_f32_16x16x32_bf16 v[36:39], a[228:231], v[96:99], v[36:39]
    buffer_load_dwordx4 v[92:95], v8, s[24:27], s42 offen sc1
    v_mfma_f32_16x16x32_bf16 v[48:51], a[232:235], v[96:99], v[48:51]
    v_mfma_f32_16x16x32_bf16 v[60:63], a[236:239], v[96:99], v[60:63]
    v_mfma_f32_16x16x32_bf16 v[72:75], a[240:243], v[96:99], v[72:75]
    buffer_load_dwordx4 v[96:99], v9, s[24:27], s42 offen sc1
    s_add_u32 s42, s42, 1024
    s_waitcnt vmcnt(12) lgkmcnt(0)
    v_mfma_f32_16x16x32_bf16 v[28:31], a[100:103], v[100:103], v[28:31]
    ds_read_b64_tr_b16 a[228:229], v16 offset:49152
    ds_read_b64_tr_b16 a[230:231], v16 offset:51200
    v_mfma_f32_16x16x32_bf16 v[40:43], a[104:107], v[100:103], v[40:43]
    ds_read_b64_tr_b16 a[232:233], v17 offset:49152
    ds_read_b64_tr_b16 a[234:235], v17 offset:51200
    v_mfma_f32_16x16x32_bf16 v[52:55], a[108:111], v[100:103], v[52:55]
    ds_read_b64_tr_b16 a[236:237], v18 offset:49152
    ds_read_b64_tr_b16 a[238:239], v18 offset:51200
    v_mfma_f32_16x16x32_bf16 v[64:67], a[112:115], v[100:103], v[64:67]
    ds_read_b64_tr_b16 a[240:241], v19 offset:49152
    ds_read_b64_tr_b16 a[242:243], v19 offset:51200
    v_mfma_f32_16x16x32_bf16 v[32:35], a[100:103], v[104:107], v[32:35]
    v_mfma_f32_16x16x32_bf16 v[44:47], a[104:107], v[104:107], v[44:47]
    v_mfma_f32_16x16x32_bf16 v[56:59], a[108:111], v[104:107], v[56:59]
    v_mfma_f32_16x16x32_bf16 v[68:71], a[112:115], v[104:107], v[68:71]
    v_mfma_f32_16x16x32_bf16 v[36:39], a[100:103], v[108:111], v[36:39]
    v_mfma_f32_16x16x32_bf16 v[48:51], a[104:107], v[108:111], v[48:51]
    v_mfma_f32_16x16x32_bf16 v[60:63], a[108:111], v[108:111], v[60:63]
    v_mfma_f32_16x16x32_bf16 v[72:75], a[112:115], v[108:111], v[72:75]
    s_waitcnt vmcnt(9) lgkmcnt(0)
    v_mfma_f32_16x16x32_bf16 v[28:31], a[228:231], v[112:115], v[28:31]
    ds_read_b64_tr_b16 a[100:101], v20 offset:32768
    ds_read_b64_tr_b16 a[102:103], v20 offset:34816
    v_mfma_f32_16x16x32_bf16 v[40:43], a[232:235], v[112:115], v[40:43]
    ds_read_b64_tr_b16 a[104:105], v21 offset:32768
    ds_read_b64_tr_b16 a[106:107], v21 offset:34816
    v_mfma_f32_16x16x32_bf16 v[52:55], a[236:239], v[112:115], v[52:55]
    ds_read_b64_tr_b16 a[108:109], v22 offset:32768
    ds_read_b64_tr_b16 a[110:111], v22 offset:34816
    v_mfma_f32_16x16x32_bf16 v[64:67], a[240:243], v[112:115], v[64:67]
    ds_read_b64_tr_b16 a[112:113], v23 offset:32768
    ds_read_b64_tr_b16 a[114:115], v23 offset:34816
    v_mfma_f32_16x16x32_bf16 v[32:35], a[228:231], v[116:119], v[32:35]
    v_mfma_f32_16x16x32_bf16 v[44:47], a[232:235], v[116:119], v[44:47]
    v_mfma_f32_16x16x32_bf16 v[56:59], a[236:239], v[116:119], v[56:59]
    v_mfma_f32_16x16x32_bf16 v[68:71], a[240:243], v[116:119], v[68:71]
    v_mfma_f32_16x16x32_bf16 v[36:39], a[228:231], v[120:123], v[36:39]
    v_mfma_f32_16x16x32_bf16 v[48:51], a[232:235], v[120:123], v[48:51]
    v_mfma_f32_16x16x32_bf16 v[60:63], a[236:239], v[120:123], v[60:63]
    v_mfma_f32_16x16x32_bf16 v[72:75], a[240:243], v[120:123], v[72:75]
    s_waitcnt vmcnt(6) lgkmcnt(0)
    v_mfma_f32_16x16x32_bf16 v[28:31], a[100:103], v[124:127], v[28:31]
    ds_read_b64_tr_b16 a[228:229], v20 offset:49152
    ds_read_b64_tr_b16 a[230:231], v20 offset:51200
    v_mfma_f32_16x16x32_bf16 v[40:43], a[104:107], v[124:127], v[40:43]
    ds_read_b64_tr_b16 a[232:233], v21 offset:49152
    ds_read_b64_tr_b16 a[234:235], v21 offset:51200
    v_mfma_f32_16x16x32_bf16 v[52:55], a[108:111], v[124:127], v[52:55]
    ds_read_b64_tr_b16 a[236:237], v22 offset:49152
    ds_read_b64_tr_b16 a[238:239], v22 offset:51200
    v_mfma_f32_16x16x32_bf16 v[64:67], a[112:115], v[124:127], v[64:67]
    ds_read_b64_tr_b16 a[240:241], v23 offset:49152
    ds_read_b64_tr_b16 a[242:243], v23 offset:51200
    v_mfma_f32_16x16x32_bf16 v[32:35], a[100:103], v[128:131], v[32:35]
    v_mfma_f32_16x16x32_bf16 v[44:47], a[104:107], v[128:131], v[44:47]
    v_mfma_f32_16x16x32_bf16 v[56:59], a[108:111], v[128:131], v[56:59]
    v_mfma_f32_16x16x32_bf16 v[68:71], a[112:115], v[128:131], v[68:71]
    v_mfma_f32_16x16x32_bf16 v[36:39], a[100:103], v[132:135], v[36:39]
    v_mfma_f32_16x16x32_bf16 v[48:51], a[104:107], v[132:135], v[48:51]
    v_mfma_f32_16x16x32_bf16 v[60:63], a[108:111], v[132:135], v[60:63]
    v_mfma_f32_16x16x32_bf16 v[72:75], a[112:115], v[132:135], v[72:75]
    s_waitcnt vmcnt(3) lgkmcnt(0)
    v_mfma_f32_16x16x32_bf16 v[28:31], a[228:231], v[76:79], v[28:31]
    ds_read_b64_tr_b16 a[100:101], v24 offset:0
    ds_read_b64_tr_b16 a[102:103], v24 offset:2048
    v_mfma_f32_16x16x32_bf16 v[40:43], a[232:235], v[76:79], v[40:43]
    ds_read_b64_tr_b16 a[104:105], v25 offset:0
    ds_read_b64_tr_b16 a[106:107], v25 offset:2048
    v_mfma_f32_16x16x32_bf16 v[52:55], a[236:239], v[76:79], v[52:55]
    ds_read_b64_tr_b16 a[108:109], v26 offset:0
    ds_read_b64_tr_b16 a[110:111], v26 offset:2048
    v_mfma_f32_16x16x32_bf16 v[64:67], a[240:243], v[76:79], v[64:67]
    ds_read_b64_tr_b16 a[112:113], v27 offset:0
    ds_read_b64_tr_b16 a[114:115], v27 offset:2048
    v_mfma_f32_16x16x32_bf16 v[32:35], a[228:231], v[80:83], v[32:35]
    v_mfma_f32_16x16x32_bf16 v[44:47], a[232:235], v[80:83], v[44:47]
    v_mfma_f32_16x16x32_bf16 v[56:59], a[236:239], v[80:83], v[56:59]
    v_mfma_f32_16x16x32_bf16 v[68:71], a[240:243], v[80:83], v[68:71]
    v_mfma_f32_16x16x32_bf16 v[36:39], a[228:231], v[84:87], v[36:39]
    v_mfma_f32_16x16x32_bf16 v[48:51], a[232:235], v[84:87], v[48:51]
    v_mfma_f32_16x16x32_bf16 v[60:63], a[236:239], v[84:87], v[60:63]
    v_mfma_f32_16x16x32_bf16 v[72:75], a[240:243], v[84:87], v[72:75]
    s_waitcnt vmcnt(0) lgkmcnt(0)
    v_mfma_f32_16x16x32_bf16 v[28:31], a[100:103], v[88:91], v[28:31]
    v_mfma_f32_16x16x32_bf16 v[40:43], a[104:107], v[88:91], v[40:43]
    v_mfma_f32_16x16x32_bf16 v[52:55], a[108:111], v[88:91], v[52:55]
    v_mfma_f32_16x16x32_bf16 v[64:67], a[112:115], v[88:91], v[64:67]
    v_mfma_f32_16x16x32_bf16 v[32:35], a[100:103], v[92:95], v[32:35]
    v_mfma_f32_16x16x32_bf16 v[44:47], a[104:107], v[92:95], v[44:47]
    v_mfma_f32_16x16x32_bf16 v[56:59], a[108:111], v[92:95], v[56:59]
    v_mfma_f32_16x16x32_bf16 v[68:71], a[112:115], v[92:95], v[68:71]
    v_mfma_f32_16x16x32_bf16 v[36:39], a[100:103], v[96:99], v[36:39]
    v_mfma_f32_16x16x32_bf16 v[48:51], a[104:107], v[96:99], v[48:51]
    v_mfma_f32_16x16x32_bf16 v[60:63], a[108:111], v[96:99], v[60:63]
    v_mfma_f32_16x16x32_bf16 v[72:75], a[112:115], v[96:99], v[72:75]
    v_lshlrev_b32 v10, 4, v2
    v_add_u32 v11, s44, v10
    s_lshl_b32 s34, s3, 10
    v_add_u32 v14, s34, v10
    s_mul_i32 s34, s40, 55296
    s_lshl_b32 s35, s41, 7
    s_add_u32 s34, s34, s35
    s_lshl_b32 s35, s3, 5
    s_add_u32 s34, s34, s35
    v_and_b32 v12, 15, v2
    v_mul_u32_u24 v12, 1152, v12
    v_lshrrev_b32 v13, 4, v2
    v_lshl_add_u32 v12, v13, 3, v12
    ds_write_b128 v11, v[28:31] offset:0
    ds_write_b128 v11, v[40:43] offset:1024
    ds_write_b128 v11, v[52:55] offset:2048
    ds_write_b128 v11, v[64:67] offset:3072
    ds_write_b128 v11, v[32:35] offset:16384
    ds_write_b128 v11, v[44:47] offset:17408
    ds_write_b128 v11, v[56:59] offset:18432
    ds_write_b128 v11, v[68:71] offset:19456
    ds_write_b128 v11, v[36:39] offset:32768
    ds_write_b128 v11, v[48:51] offset:33792
    ds_write_b128 v11, v[60:63] offset:34816
    ds_write_b128 v11, v[72:75] offset:35840
    s_waitcnt lgkmcnt(0)
    s_barrier
    ds_read_b128 v[80:83], v14 offset:0
    ds_read_b128 v[84:87], v14 offset:4096
    ds_read_b128 v[88:91], v14 offset:8192
    ds_read_b128 v[92:95], v14 offset:12288
    ds_read_b128 v[96:99], v14 offset:16384
    ds_read_b128 v[100:103], v14 offset:20480
    ds_read_b128 v[104:107], v14 offset:24576
    ds_read_b128 v[108:111], v14 offset:28672
    ds_read_b128 v[112:115], v14 offset:32768
    ds_read_b128 v[116:119], v14 offset:36864
    ds_read_b128 v[120:123], v14 offset:40960
    ds_read_b128 v[124:127], v14 offset:45056
    s_waitcnt lgkmcnt(8)
    v_pk_add_f32 v[80:81], v[80:81], v[84:85]
    v_pk_add_f32 v[88:89], v[88:89], v[92:93]
    v_pk_add_f32 v[82:83], v[82:83], v[86:87]
    v_pk_add_f32 v[90:91], v[90:91], v[94:95]
    v_pk_add_f32 v[80:81], v[80:81], v[88:89]
    v_pk_add_f32 v[82:83], v[82:83], v[90:91]
    v_cvt_pk_bf16_f32 v140, v80, v81
    v_cvt_pk_bf16_f32 v141, v82, v83
    buffer_store_dwordx2 v[140:141], v12, s[56:59], s34 offen
    s_add_u32 s34, s34, 18432
    s_waitcnt lgkmcnt(4)
    v_pk_add_f32 v[96:97], v[96:97], v[100:101]
    v_pk_add_f32 v[104:105], v[104:105], v[108:109]
    v_pk_add_f32 v[98:99], v[98:99], v[102:103]
    v_pk_add_f32 v[106:107], v[106:107], v[110:111]
    v_pk_add_f32 v[96:97], v[96:97], v[104:105]
    v_pk_add_f32 v[98:99], v[98:99], v[106:107]
    v_cvt_pk_bf16_f32 v142, v96, v97
    v_cvt_pk_bf16_f32 v143, v98, v99
    buffer_store_dwordx2 v[142:143], v12, s[56:59], s34 offen
    s_add_u32 s34, s34, 18432
    s_waitcnt lgkmcnt(0)
    v_pk_add_f32 v[112:113], v[112:113], v[116:117]
    v_pk_add_f32 v[120:121], v[120:121], v[124:125]
    v_pk_add_f32 v[114:115], v[114:115], v[118:119]
    v_pk_add_f32 v[122:123], v[122:123], v[126:127]
    v_pk_add_f32 v[112:113], v[112:113], v[120:121]
    v_pk_add_f32 v[114:115], v[114:115], v[122:123]
    v_cvt_pk_bf16_f32 v144, v112, v113
    v_cvt_pk_bf16_f32 v145, v114, v115
    buffer_store_dwordx2 v[144:145], v12, s[56:59], s34 offen
    s_branch L_k1_end
L_t_tailwg:
    s_waitcnt vmcnt(0)
    s_barrier
    s_cmp_lg_u32 s3, 0
    s_cbranch_scc1 L_t_nosig2
    s_lshl_b32 s34, s7, 5
    v_mov_b32 v10, s34
    v_mov_b32 v11, 1
    s_mov_b64 exec, 1
    buffer_atomic_add v11, v10, s[92:95], 0 offen sc1
    s_mov_b64 exec, -1
L_t_nosig2:
    s_waitcnt vmcnt(0)
    s_branch L_k1_end
L_fallback:
    s_waitcnt vmcnt(0) lgkmcnt(0)
    s_barrier
    v_mov_b32 v244, 0xff800000
    v_mov_b32 v245, 0xff800000
    v_mov_b32 v246, 0xff800000
    v_mov_b32 v247, 0xff800000
    v_mov_b32 v248, 0xff800000
    s_sub_u32 s30, s101, 262144
    s_mov_b32 s32, 0
L_fb_loop:
    s_mov_b32 m0, s31
    s_nop 0
    buffer_load_dwordx4 v236, s[12:15], s30 offen offset:0 lds
    buffer_load_dwordx4 v237, s[12:15], s30 offen offset:1024 lds
    buffer_load_dwordx4 v238, s[12:15], s30 offen offset:2048 lds
    buffer_load_dwordx4 v239, s[12:15], s30 offen offset:3072 lds
    s_waitcnt vmcnt(0)
    s_barrier
    ds_read_b128 a[100:103], v224 offset:0
    ds_read_b128 a[104:107], v225 offset:0
    ds_read_b128 a[108:111], v226 offset:0
    ds_read_b128 a[112:115], v227 offset:0
    ds_read_b128 a[116:119], v224 offset:4096
    ds_read_b128 a[120:123], v225 offset:4096
    ds_read_b128 a[124:127], v226 offset:4096
    ds_read_b128 a[128:131], v227 offset:4096
    s_waitcnt lgkmcnt(0)
    s_barrier
    v_mfma_f32_16x16x32_bf16 v[176:179], a[100:103], v[16:19], 0
    v_mfma_f32_16x16x32_bf16 v[176:179], a[104:107], v[20:23], v[176:179]
    v_mfma_f32_16x16x32_bf16 v[176:179], a[108:111], v[24:27], v[176:179]
    v_mfma_f32_16x16x32_bf16 v[176:179], a[112:115], v[28:31], v[176:179]
    v_mfma_f32_16x16x32_bf16 v[180:183], a[116:119], v[16:19], 0
    v_mfma_f32_16x16x32_bf16 v[180:183], a[120:123], v[20:23], v[180:183]
    v_mfma_f32_16x16x32_bf16 v[180:183], a[124:127], v[24:27], v[180:183]
    v_mfma_f32_16x16x32_bf16 v[180:183], a[128:131], v[28:31], v[180:183]
    s_nop 7
    v_max3_f32 v244, v244, v176, v177
    v_max3_f32 v244, v244, v178, v179
    v_max3_f32 v244, v244, v180, v181
    v_max3_f32 v244, v244, v182, v183
    v_mfma_f32_16x16x32_bf16 v[176:179], a[100:103], v[32:35], 0
    v_mfma_f32_16x16x32_bf16 v[176:179], a[104:107], v[36:39], v[176:179]
    v_mfma_f32_16x16x32_bf16 v[176:179], a[108:111], v[40:43], v[176:179]
    v_mfma_f32_16x16x32_bf16 v[176:179], a[112:115], v[44:47], v[176:179]
    v_mfma_f32_16x16x32_bf16 v[180:183], a[116:119], v[32:35], 0
    v_mfma_f32_16x16x32_bf16 v[180:183], a[120:123], v[36:39], v[180:183]
    v_mfma_f32_16x16x32_bf16 v[180:183], a[124:127], v[40:43], v[180:183]
    v_mfma_f32_16x16x32_bf16 v[180:183], a[128:131], v[44:47], v[180:183]
    s_nop 7
    v_max3_f32 v245, v245, v176, v177
    v_max3_f32 v245, v245, v178, v179
    v_max3_f32 v245, v245, v180, v181
    v_max3_f32 v245, v245, v182, v183
    v_mfma_f32_16x16x32_bf16 v[176:179], a[100:103], v[48:51], 0
    v_mfma_f32_16x16x32_bf16 v[176:179], a[104:107], v[52:55], v[176:179]
    v_mfma_f32_16x16x32_bf16 v[176:179], a[108:111], v[56:59], v[176:179]
    v_mfma_f32_16x16x32_bf16 v[176:179], a[112:115], v[60:63], v[176:179]
    v_mfma_f32_16x16x32_bf16 v[180:183], a[116:119], v[48:51], 0
    v_mfma_f32_16x16x32_bf16 v[180:183], a[120:123], v[52:55], v[180:183]
    v_mfma_f32_16x16x32_bf16 v[180:183], a[124:127], v[56:59], v[180:183]
    v_mfma_f32_16x16x32_bf16 v[180:183], a[128:131], v[60:63], v[180:183]
    s_nop 7
    v_max3_f32 v246, v246, v176, v177
    v_max3_f32 v246, v246, v178, v179
    v_max3_f32 v246, v246, v180, v181
    v_max3_f32 v246, v246, v182, v183
    v_mfma_f32_16x16x32_bf16 v[176:179], a[100:103], v[64:67], 0
    v_mfma_f32_16x16x32_bf16 v[176:179], a[104:107], v[68:71], v[176:179]
    v_mfma_f32_16x16x32_bf16 v[176:179], a[108:111], v[72:75], v[176:179]
    v_mfma_f32_16x16x32_bf16 v[176:179], a[112:115], v[76:79], v[176:179]
    v_mfma_f32_16x16x32_bf16 v[180:183], a[116:119], v[64:67], 0
    v_mfma_f32_16x16x32_bf16 v[180:183], a[120:123], v[68:71], v[180:183]
    v_mfma_f32_16x16x32_bf16 v[180:183], a[124:127], v[72:75], v[180:183]
    v_mfma_f32_16x16x32_bf16 v[180:183], a[128:131], v[76:79], v[180:183]
    s_nop 7
    v_max3_f32 v247, v247, v176, v177
    v_max3_f32 v247, v247, v178, v179
    v_max3_f32 v247, v247, v180, v181
    v_max3_f32 v247, v247, v182, v183
    v_mfma_f32_16x16x32_bf16 v[176:179], a[100:103], v[80:83], 0
    v_mfma_f32_16x16x32_bf16 v[176:179], a[104:107], v[84:87], v[176:179]
    v_mfma_f32_16x16x32_bf16 v[176:179], a[108:111], v[88:91], v[176:179]
    v_mfma_f32_16x16x32_bf16 v[176:179], a[112:115], v[92:95], v[176:179]
    v_mfma_f32_16x16x32_bf16 v[180:183], a[116:119], v[80:83], 0
    v_mfma_f32_16x16x32_bf16 v[180:183], a[120:123], v[84:87], v[180:183]
    v_mfma_f32_16x16x32_bf16 v[180:183], a[124:127], v[88:91], v[180:183]
    v_mfma_f32_16x16x32_bf16 v[180:183], a[128:131], v[92:95], v[180:183]
    s_nop 7
    v_max3_f32 v248, v248, v176, v177
    v_max3_f32 v248, v248, v178, v179
    v_max3_f32 v248, v248, v180, v181
    v_max3_f32 v248, v248, v182, v183
    s_add_u32 s30, s30, 8192
    s_add_u32 s32, s32, 1
    s_cmp_lt_u32 s32, 32
    s_cbranch_scc1 L_fb_loop
    s_mul_i32 s34, s3, 1280
    s_add_u32 s34, s34, 131072
    v_lshlrev_b32 v251, 2, v2
    v_add_u32 v250, s34, v251
    ds_write_b32 v250, v244 offset:0
    ds_write_b32 v250, v245 offset:256
    ds_write_b32 v250, v246 offset:512
    ds_write_b32 v250, v247 offset:768
    ds_write_b32 v250, v248 offset:1024
    s_waitcnt lgkmcnt(0)
    s_barrier
    v_and_b32 v251, 15, v2
    v_lshlrev_b32 v251, 2, v251
    s_mul_i32 s34, s4, 1280
    s_add_u32 s34, s34, 131072
    v_add_u32 v251, s34, v251
    ds_read_b32 v176, v251 offset:0
    ds_read_b32 v177, v251 offset:64
    ds_read_b32 v178, v251 offset:128
    ds_read_b32 v179, v251 offset:192
    ds_read_b32 v180, v251 offset:2560
    ds_read_b32 v181, v251 offset:2624
    ds_read_b32 v182, v251 offset:2688
    ds_read_b32 v183, v251 offset:2752
    s_waitcnt lgkmcnt(0)
    v_max3_f32 v252, v176, v177, v178
    v_max3_f32 v252, v252, v179, v180
    v_max3_f32 v252, v252, v181, v182
    v_max_f32 v252, v252, v183
    v_sub_f32 v200, 0, v252
    v_sub_f32 v201, 0, v252
    v_sub_f32 v202, 0, v252
    v_sub_f32 v203, 0, v252
    ds_read_b32 v176, v251 offset:256
    ds_read_b32 v177, v251 offset:320
    ds_read_b32 v178, v251 offset:384
    ds_read_b32 v179, v251 offset:448
    ds_read_b32 v180, v251 offset:2816
    ds_read_b32 v181, v251 offset:2880
    ds_read_b32 v182, v251 offset:2944
    ds_read_b32 v183, v251 offset:3008
    s_waitcnt lgkmcnt(0)
    v_max3_f32 v252, v176, v177, v178
    v_max3_f32 v252, v252, v179, v180
    v_max3_f32 v252, v252, v181, v182
    v_max_f32 v252, v252, v183
    v_sub_f32 v204, 0, v252
    v_sub_f32 v205, 0, v252
    v_sub_f32 v206, 0, v252
    v_sub_f32 v207, 0, v252
    ds_read_b32 v176, v251 offset:512
    ds_read_b32 v177, v251 offset:576
    ds_read_b32 v178, v251 offset:640
    ds_read_b32 v179, v251 offset:704
    ds_read_b32 v180, v251 offset:3072
    ds_read_b32 v181, v251 offset:3136
    ds_read_b32 v182, v251 offset:3200
    ds_read_b32 v183, v251 offset:3264
    s_waitcnt lgkmcnt(0)
    v_max3_f32 v252, v176, v177, v178
    v_max3_f32 v252, v252, v179, v180
    v_max3_f32 v252, v252, v181, v182
    v_max_f32 v252, v252, v183
    v_sub_f32 v208, 0, v252
    v_sub_f32 v209, 0, v252
    v_sub_f32 v210, 0, v252
    v_sub_f32 v211, 0, v252
    ds_read_b32 v176, v251 offset:768
    ds_read_b32 v177, v251 offset:832
    ds_read_b32 v178, v251 offset:896
    ds_read_b32 v179, v251 offset:960
    ds_read_b32 v180, v251 offset:3328
    ds_read_b32 v181, v251 offset:3392
    ds_read_b32 v182, v251 offset:3456
    ds_read_b32 v183, v251 offset:3520
    s_waitcnt lgkmcnt(0)
    v_max3_f32 v252, v176, v177, v178
    v_max3_f32 v252, v252, v179, v180
    v_max3_f32 v252, v252, v181, v182
    v_max_f32 v252, v252, v183
    v_sub_f32 v212, 0, v252
    v_sub_f32 v213, 0, v252
    v_sub_f32 v214, 0, v252
    v_sub_f32 v215, 0, v252
    ds_read_b32 v176, v251 offset:1024
    ds_read_b32 v177, v251 offset:1088
    ds_read_b32 v178, v251 offset:1152
    ds_read_b32 v179, v251 offset:1216
    ds_read_b32 v180, v251 offset:3584
    ds_read_b32 v181, v251 offset:3648
    ds_read_b32 v182, v251 offset:3712
    ds_read_b32 v183, v251 offset:3776
    s_waitcnt lgkmcnt(0)
    v_max3_f32 v252, v176, v177, v178
    v_max3_f32 v252, v252, v179, v180
    v_max3_f32 v252, v252, v181, v182
    v_max_f32 v252, v252, v183
    v_sub_f32 v216, 0, v252
    v_sub_f32 v217, 0, v252
    v_sub_f32 v218, 0, v252
    v_sub_f32 v219, 0, v252
    v_accvgpr_write_b32 a0, 0
    v_accvgpr_write_b32 a1, 0
    v_accvgpr_write_b32 a2, 0
    v_accvgpr_write_b32 a3, 0
    v_accvgpr_write_b32 a4, 0
    v_accvgpr_write_b32 a5, 0
    v_accvgpr_write_b32 a6, 0
    v_accvgpr_write_b32 a7, 0
    v_accvgpr_write_b32 a8, 0
    v_accvgpr_write_b32 a9, 0
    v_accvgpr_write_b32 a10, 0
    v_accvgpr_write_b32 a11, 0
    v_accvgpr_write_b32 a12, 0
    v_accvgpr_write_b32 a13, 0
    v_accvgpr_write_b32 a14, 0
    v_accvgpr_write_b32 a15, 0
    v_accvgpr_write_b32 a16, 0
    v_accvgpr_write_b32 a17, 0
    v_accvgpr_write_b32 a18, 0
    v_accvgpr_write_b32 a19, 0
    v_accvgpr_write_b32 a20, 0
    v_accvgpr_write_b32 a21, 0
    v_accvgpr_write_b32 a22, 0
    v_accvgpr_write_b32 a23, 0
    v_accvgpr_write_b32 a24, 0
    v_accvgpr_write_b32 a25, 0
    v_accvgpr_write_b32 a26, 0
    v_accvgpr_write_b32 a27, 0
    v_accvgpr_write_b32 a28, 0
    v_accvgpr_write_b32 a29, 0
    v_accvgpr_write_b32 a30, 0
    v_accvgpr_write_b32 a31, 0
    v_accvgpr_write_b32 a32, 0
    v_accvgpr_write_b32 a33, 0
    v_accvgpr_write_b32 a34, 0
    v_accvgpr_write_b32 a35, 0
    v_accvgpr_write_b32 a36, 0
    v_accvgpr_write_b32 a37, 0
    v_accvgpr_write_b32 a38, 0
    v_accvgpr_write_b32 a39, 0
    v_accvgpr_write_b32 a40, 0
    v_accvgpr_write_b32 a41, 0
    v_accvgpr_write_b32 a42, 0
    v_accvgpr_write_b32 a43, 0
    v_accvgpr_write_b32 a44, 0
    v_accvgpr_write_b32 a45, 0
    v_accvgpr_write_b32 a46, 0
    v_accvgpr_write_b32 a47, 0
    v_accvgpr_write_b32 a48, 0
    v_accvgpr_write_b32 a49, 0
    v_accvgpr_write_b32 a50, 0
    v_accvgpr_write_b32 a51, 0
    v_accvgpr_write_b32 a52, 0
    v_accvgpr_write_b32 a53, 0
    v_accvgpr_write_b32 a54, 0
    v_accvgpr_write_b32 a55, 0
    v_accvgpr_write_b32 a56, 0
    v_accvgpr_write_b32 a57, 0
    v_accvgpr_write_b32 a58, 0
    v_accvgpr_write_b32 a59, 0
    v_accvgpr_write_b32 a60, 0
    v_accvgpr_write_b32 a61, 0
    v_accvgpr_write_b32 a62, 0
    v_accvgpr_write_b32 a63, 0
    v_accvgpr_write_b32 a64, 0
    v_accvgpr_write_b32 a65, 0
    v_accvgpr_write_b32 a66, 0
    v_accvgpr_write_b32 a67, 0
    v_accvgpr_write_b32 a68, 0
    v_accvgpr_write_b32 a69, 0
    v_accvgpr_write_b32 a70, 0
    v_accvgpr_write_b32 a71, 0
    v_accvgpr_write_b32 a72, 0
    v_accvgpr_write_b32 a73, 0
    v_accvgpr_write_b32 a74, 0
    v_accvgpr_write_b32 a75, 0
    v_accvgpr_write_b32 a76, 0
    v_accvgpr_write_b32 a77, 0
    v_accvgpr_write_b32 a78, 0
    v_accvgpr_write_b32 a79, 0
    v_accvgpr_write_b32 a80, 0
    v_accvgpr_write_b32 a81, 0
    v_accvgpr_write_b32 a82, 0
    v_accvgpr_write_b32 a83, 0
    v_accvgpr_write_b32 a84, 0
    v_accvgpr_write_b32 a85, 0
    v_accvgpr_write_b32 a86, 0
    v_accvgpr_write_b32 a87, 0
    v_accvgpr_write_b32 a88, 0
    v_accvgpr_write_b32 a89, 0
    v_accvgpr_write_b32 a90, 0
    v_accvgpr_write_b32 a91, 0
    v_accvgpr_write_b32 a92, 0
    v_accvgpr_write_b32 a93, 0
    v_accvgpr_write_b32 a94, 0
    v_accvgpr_write_b32 a95, 0
    v_accvgpr_write_b32 a96, 0
    v_accvgpr_write_b32 a97, 0
    v_accvgpr_write_b32 a98, 0
    v_accvgpr_write_b32 a99, 0
    v_accvgpr_write_b32 a196, 0
    v_accvgpr_write_b32 a197, 0
    v_accvgpr_write_b32 a198, 0
    v_accvgpr_write_b32 a199, 0
    v_accvgpr_write_b32 a200, 0
    v_accvgpr_write_b32 a201, 0
    v_accvgpr_write_b32 a202, 0
    v_accvgpr_write_b32 a203, 0
    v_accvgpr_write_b32 a204, 0
    v_accvgpr_write_b32 a205, 0
    v_accvgpr_write_b32 a206, 0
    v_accvgpr_write_b32 a207, 0
    v_accvgpr_write_b32 a208, 0
    v_accvgpr_write_b32 a209, 0
    v_accvgpr_write_b32 a210, 0
    v_accvgpr_write_b32 a211, 0
    v_accvgpr_write_b32 a212, 0
    v_accvgpr_write_b32 a213, 0
    v_accvgpr_write_b32 a214, 0
    v_accvgpr_write_b32 a215, 0
    v_accvgpr_write_b32 a216, 0
    v_accvgpr_write_b32 a217, 0
    v_accvgpr_write_b32 a218, 0
    v_accvgpr_write_b32 a219, 0
    v_accvgpr_write_b32 a220, 0
    v_accvgpr_write_b32 a221, 0
    v_accvgpr_write_b32 a222, 0
    v_accvgpr_write_b32 a223, 0
    v_accvgpr_write_b32 a224, 0
    v_accvgpr_write_b32 a225, 0
    v_accvgpr_write_b32 a226, 0
    v_accvgpr_write_b32 a227, 0
    v_mov_b32 v196, 0
    v_mov_b32 v197, 0
    v_mov_b32 v198, 0
    v_mov_b32 v199, 0
    v_pk_mov_b32 v[96:97], 0, 0
    v_pk_mov_b32 v[98:99], 0, 0
    v_pk_mov_b32 v[100:101], 0, 0
    v_pk_mov_b32 v[102:103], 0, 0
    v_pk_mov_b32 v[104:105], 0, 0
    v_pk_mov_b32 v[106:107], 0, 0
    v_pk_mov_b32 v[108:109], 0, 0
    v_pk_mov_b32 v[110:111], 0, 0
    v_pk_mov_b32 v[112:113], 0, 0
    v_pk_mov_b32 v[114:115], 0, 0
    v_pk_mov_b32 v[116:117], 0, 0
    v_pk_mov_b32 v[118:119], 0, 0
    v_pk_mov_b32 v[120:121], 0, 0
    v_pk_mov_b32 v[122:123], 0, 0
    v_pk_mov_b32 v[124:125], 0, 0
    v_pk_mov_b32 v[126:127], 0, 0
    v_pk_mov_b32 v[128:129], 0, 0
    v_pk_mov_b32 v[130:131], 0, 0
    v_pk_mov_b32 v[132:133], 0, 0
    v_pk_mov_b32 v[134:135], 0, 0
    v_pk_mov_b32 v[136:137], 0, 0
    v_pk_mov_b32 v[138:139], 0, 0
    v_pk_mov_b32 v[140:141], 0, 0
    v_pk_mov_b32 v[142:143], 0, 0
    v_pk_mov_b32 v[144:145], 0, 0
    v_pk_mov_b32 v[146:147], 0, 0
    v_pk_mov_b32 v[148:149], 0, 0
    v_pk_mov_b32 v[150:151], 0, 0
    v_pk_mov_b32 v[152:153], 0, 0
    v_pk_mov_b32 v[154:155], 0, 0
    v_pk_mov_b32 v[156:157], 0, 0
    v_pk_mov_b32 v[158:159], 0, 0
    v_pk_mov_b32 v[160:161], 0, 0
    v_pk_mov_b32 v[162:163], 0, 0
    v_pk_mov_b32 v[164:165], 0, 0
    v_pk_mov_b32 v[166:167], 0, 0
    v_pk_mov_b32 v[168:169], 0, 0
    v_pk_mov_b32 v[170:171], 0, 0
    v_pk_mov_b32 v[172:173], 0, 0
    v_pk_mov_b32 v[174:175], 0, 0
    s_mov_b32 s33, 1
    s_mul_i32 s43, s3, 1179648
    s_mov_b32 s30, s48
    s_barrier
    s_add_u32 m0, s31, 0
    s_nop 0
    buffer_load_dwordx4 v236, s[12:15], s30 offen offset:0 nt lds
    buffer_load_dwordx4 v237, s[12:15], s30 offen offset:1024 nt lds
    buffer_load_dwordx4 v238, s[12:15], s30 offen offset:2048 nt lds
    buffer_load_dwordx4 v239, s[12:15], s30 offen offset:3072 nt lds
    s_add_u32 m0, s31, 8192
    s_nop 0
    buffer_load_dwordx4 v240, s[16:19], s30 offen offset:0 nt lds
    buffer_load_dwordx4 v241, s[16:19], s30 offen offset:1024 nt lds
    buffer_load_dwordx4 v240, s[16:19], s30 offen offset:2048 nt lds
    buffer_load_dwordx4 v241, s[16:19], s30 offen offset:3072 nt lds
    s_add_u32 s30, s30, 8192
    s_cmp_eq_u32 s30, s101
    s_cselect_b32 s30, s100, s30
    s_add_u32 m0, s31, 16384
    s_nop 0
    buffer_load_dwordx4 v236, s[12:15], s30 offen offset:0 nt lds
    buffer_load_dwordx4 v237, s[12:15], s30 offen offset:1024 nt lds
    buffer_load_dwordx4 v238, s[12:15], s30 offen offset:2048 nt lds
    buffer_load_dwordx4 v239, s[12:15], s30 offen offset:3072 nt lds
    s_add_u32 m0, s31, 24576
    s_nop 0
    buffer_load_dwordx4 v240, s[16:19], s30 offen offset:0 nt lds
    buffer_load_dwordx4 v241, s[16:19], s30 offen offset:1024 nt lds
    buffer_load_dwordx4 v240, s[16:19], s30 offen offset:2048 nt lds
    buffer_load_dwordx4 v241, s[16:19], s30 offen offset:3072 nt lds
    s_add_u32 s30, s30, 8192
    s_cmp_eq_u32 s30, s101
    s_cselect_b32 s30, s100, s30
    s_add_u32 m0, s31, 32768
    s_nop 0
    buffer_load_dwordx4 v236, s[12:15], s30 offen offset:0 nt lds
    buffer_load_dwordx4 v237, s[12:15], s30 offen offset:1024 nt lds
    buffer_load_dwordx4 v238, s[12:15], s30 offen offset:2048 nt lds
    buffer_load_dwordx4 v239, s[12:15], s30 offen offset:3072 nt lds
    s_add_u32 m0, s31, 40960
    s_nop 0
    buffer_load_dwordx4 v240, s[16:19], s30 offen offset:0 nt lds
    buffer_load_dwordx4 v241, s[16:19], s30 offen offset:1024 nt lds
    buffer_load_dwordx4 v240, s[16:19], s30 offen offset:2048 nt lds
    buffer_load_dwordx4 v241, s[16:19], s30 offen offset:3072 nt lds
    s_add_u32 s30, s30, 8192
    s_cmp_eq_u32 s30, s101
    s_cselect_b32 s30, s100, s30
    s_waitcnt vmcnt(8)
    s_barrier
    ds_read_b128 a[100:103], v224 offset:0
    ds_read_b128 a[104:107], v225 offset:0
    ds_read_b128 a[108:111], v226 offset:0
    ds_read_b128 a[112:115], v227 offset:0
    ds_read_b128 a[116:119], v224 offset:4096
    ds_read_b128 a[120:123], v225 offset:4096
    ds_read_b128 a[124:127], v226 offset:4096
    ds_read_b128 a[128:131], v227 offset:4096
    ds_read_b64_tr_b16 a[164:165], v228 offset:0
    ds_read_b64_tr_b16 a[166:167], v228 offset:4096
    ds_read_b64_tr_b16 a[168:169], v229 offset:0
    ds_read_b64_tr_b16 a[170:171], v229 offset:4096
    ds_read_b64_tr_b16 a[172:173], v230 offset:0
    ds_read_b64_tr_b16 a[174:175], v230 offset:4096
    ds_read_b64_tr_b16 a[176:177], v231 offset:0
    ds_read_b64_tr_b16 a[178:179], v231 offset:4096
    ds_read_b64_tr_b16 a[180:181], v232 offset:0
    ds_read_b64_tr_b16 a[182:183], v232 offset:4096
    ds_read_b64_tr_b16 a[184:185], v233 offset:0
    ds_read_b64_tr_b16 a[186:187], v233 offset:4096
    ds_read_b64_tr_b16 a[188:189], v234 offset:0
    ds_read_b64_tr_b16 a[190:191], v234 offset:4096
    ds_read_b64_tr_b16 a[192:193], v235 offset:0
    ds_read_b64_tr_b16 a[194:195], v235 offset:4096
    s_waitcnt lgkmcnt(0)
    s_branch L_attn0

L_k1_end:
    s_endpgm
.section .rodata,"a"
.p2align 6
.amdhsa_kernel standalone__gqa_block_cached__near_ridge_kernel
  .amdhsa_next_free_vgpr 512
  .amdhsa_next_free_sgpr 102
  .amdhsa_accum_offset 256
  .amdhsa_group_segment_fixed_size 0
  .amdhsa_kernarg_size 64
  .amdhsa_user_sgpr_count 2
  .amdhsa_user_sgpr_kernarg_segment_ptr 1
  .amdhsa_system_sgpr_workgroup_id_x 1
.end_amdhsa_kernel
```
